```python
import torch

def _softmax(x, axis=-1):
    return torch.softmax(x, dim=axis)
def _gelu(x):
    return torch.nn.functional.gelu(x, approximate="tanh")
def _silu(x):
    return torch.nn.functional.silu(x)
def _sigmoid(x):
    return torch.sigmoid(x)
def _layernorm(x, axis=-1, eps=1e-5):
    m = x.mean(dim=axis, keepdim=True)
    v = x.var(dim=axis, keepdim=True, unbiased=False)
    return (x - m) / torch.sqrt(v + eps)
def _scatter_add(tgt, idx, src, axis=0):
    return tgt.clone().index_add_(axis, idx, src)
def _segment_sum(src, seg, n):
    out = torch.zeros((n,) + src.shape[1:], dtype=src.dtype)
    return out.index_add_(0, seg, src)
def _pad(x, pw):
    flat = tuple(v for pair in reversed(pw) for v in pair)
    return torch.nn.functional.pad(x, flat)

kernel_name = 'sequential_preLN__sliding_block_cached__dense_activation_mish__decode'

def setup_inputs():

    _w = (lambda a: (lambda t: t.to(torch.bfloat16) if t.is_floating_point() else t)(torch.as_tensor(a)))
    def _A_setup():
        B, Sq, D = 1, 1, 448
        Hq, Hkv, Sk, Dh = 16, 8, 8192, 256
        assert Hq % Hkv == 0, (Hq, Hkv)
        return {
            "x": _w((lambda *s: torch.randn(*s, dtype=torch.bfloat16) * 0.05)(B, Sq, D)),
            "k_cache": _w((lambda *s: torch.randn(*s, dtype=torch.bfloat16) * 1.6)(B, Hkv, Sk, Dh)),
            "v_cache": _w((lambda *s: torch.randn(*s, dtype=torch.bfloat16) * 0.4)(B, Hkv, Sk, Dh)),
            "wq": _w((lambda *s: torch.randn(*s, dtype=torch.bfloat16) * 1.6)(D, Hq * Dh) * (D ** -0.5)),
            "wo": _w((lambda *s: torch.randn(*s, dtype=torch.bfloat16) * 0.4)(Hq * Dh, D) * ((Hq * Dh) ** -0.5)),
        }
    _A_in = _A_setup()

    def _B_setup():
        B, S, D, F = 1, 1, 448, 1792
        return {
            "x": _w((lambda *s: torch.randn(*s, dtype=torch.bfloat16) * 0.05)(B, S, D)),
            "w1": _w((lambda *s: torch.randn(*s, dtype=torch.bfloat16) * 0.8)(D, F) * (D ** -0.5)),
            "b1": _w((lambda *s: torch.randn(*s, dtype=torch.bfloat16) * 0.2)(F)),
            "w2": _w((lambda *s: torch.randn(*s, dtype=torch.bfloat16) * 0.1)(F, D) * (F ** -0.5)),
        }
    _B_in = _B_setup()

    return {
        "A_x": _A_in["x"],
        "A_k_cache": _A_in["k_cache"],
        "A_v_cache": _A_in["v_cache"],
        "A_wq": _A_in["wq"],
        "A_wo": _A_in["wo"],
        "B_x": _B_in["x"],
        "B_w1": _B_in["w1"],
        "B_b1": _B_in["b1"],
        "B_w2": _B_in["w2"],
    }

def reference(A_x, A_k_cache, A_v_cache, A_wq, A_wo, B_x, B_w1, B_b1, B_w2):
    def _A_ref(x, k_cache, v_cache, wq, wo):
        B, Sq, D = x.shape
        Hq, Dh = 16, 256
        Hkv, Sk = k_cache.shape[1], k_cache.shape[2]
        W = min(4096, max(256, Sk // 4))
        rep = Hq // Hkv
        q = (lambda x, *d: x.permute(*d))((x @ wq).reshape(B, Sq, Hq, Dh), 0, 2, 1, 3)
        k = (lambda x, n, axis: torch.repeat_interleave(x, n, dim=axis))(k_cache[:, :, Sk - W:, :], rep, axis=1)
        v = (lambda x, n, axis: torch.repeat_interleave(x, n, dim=axis))(v_cache[:, :, Sk - W:, :], rep, axis=1)
        scores = torch.einsum("bhqd,bhkd->bhqk", q, k) * (Dh ** -0.5)
        p = _softmax(scores, axis=-1)
        o = torch.einsum("bhqk,bhkd->bhqd", p, v)
        return (lambda x, *d: x.permute(*d))(o, 0, 2, 1, 3).reshape(B, Sq, Hq * Dh) @ wo

    def _B_ref(x, w1, b1, w2):
        h = torch.einsum("bsd,df->bsf", x, w1) + b1
        sp = torch.log1p(torch.exp(-torch.abs(h))) + torch.where(h > 0, h, torch.zeros_like(h))
        act = h * torch.tanh(sp)
        return torch.einsum("bsf,fd->bsd", act, w2)

    x = A_x
    h = x + _A_ref(_layernorm(x, axis=-1), A_k_cache, A_v_cache, A_wq, A_wo)
    h2 = h + _B_ref(_layernorm(h, axis=-1), B_w1, B_b1, B_w2)
    return h2
```

```asm
; @launch grid=(256,1,1) block=(512,1,1) lds=45056
.amdgcn_target "amdgcn-amd-amdhsa--gfx950"
.text
.globl sequential_preLN__sliding_block_cached__dense_activation_mish__decode_kernel
.p2align 8
.type sequential_preLN__sliding_block_cached__dense_activation_mish__decode_kernel,@function
sequential_preLN__sliding_block_cached__dense_activation_mish__decode_kernel:
    s_load_dwordx16 s[4:19], s[0:1], 0
    s_load_dwordx8 s[20:27], s[0:1], 64
    s_cmp_ge_u32 s2, 256
    s_cbranch_scc1 L_exit
    v_lshrrev_b32 v4, 6, v0
    v_and_b32 v3, 63, v0
    v_readfirstlane_b32 s34, v4
    v_and_b32 v1, 15, v0
    v_bfe_u32 v2, v0, 4, 2
    s_and_b32 s32, s2, 7
    s_lshr_b32 s33, s2, 3
    s_and_b32 s35, s34, 3
    s_cmp_ge_u32 s34, 4
    s_cbranch_scc1 L_tail
    s_lshl_b32 s48, s32, 22
    s_lshl_b32 s49, s33, 15
    s_add_u32 s48, s48, s49
    s_lshl_b32 s49, s34, 13
    s_add_u32 s48, s48, s49
    s_add_u32 s48, s48, 3145728
    v_lshrrev_b32 v4, 3, v3
    v_lshlrev_b32 v4, 9, v4
    v_and_b32 v5, 7, v3
    v_lshl_add_u32 v4, v5, 4, v4
    s_add_u32 s54, s48, 4096
    s_add_u32 s49, s49, 12288
    v_lshlrev_b32 v5, 11, v2
    v_lshl_add_u32 v5, v1, 4, v5
    s_mov_b32 s42, 33554432
    s_mov_b32 s43, 0x20000
    s_mov_b32 s46, 33554432
    s_mov_b32 s47, 0x20000
    s_waitcnt lgkmcnt(0)
    s_mov_b32 s40, s6
    s_and_b32 s41, s7, 0xffff
    s_mov_b32 s44, s8
    s_and_b32 s45, s9, 0xffff
    s_barrier
    s_add_u32 m0, s49, 0
    s_nop 0
    buffer_load_dwordx4 v4, s[40:43], s48 offen offset:0 nt lds
    s_add_u32 m0, s49, 1024
    s_nop 0
    buffer_load_dwordx4 v4, s[40:43], s54 offen offset:0 nt lds
    s_add_u32 m0, s49, 1920
    s_nop 0
    buffer_load_dwordx4 v4, s[40:43], s48 offen offset:128 nt lds
    s_add_u32 m0, s49, 2944
    s_nop 0
    buffer_load_dwordx4 v4, s[40:43], s54 offen offset:128 nt lds
    s_add_u32 m0, s49, 3840
    s_nop 0
    buffer_load_dwordx4 v4, s[40:43], s48 offen offset:256 nt lds
    s_add_u32 m0, s49, 4864
    s_nop 0
    buffer_load_dwordx4 v4, s[40:43], s54 offen offset:256 nt lds
    s_add_u32 m0, s49, 5760
    s_nop 0
    buffer_load_dwordx4 v4, s[40:43], s48 offen offset:384 nt lds
    s_load_dwordx4 s[28:31], s[26:27], 0
    s_mov_b32 s36, s26
    s_and_b32 s37, s27, 0xffff
    s_mov_b32 s38, 4194304
    s_mov_b32 s39, 0x20000
    v_and_b32 v10, 1, v1
    v_lshlrev_b32 v10, 4, v10
    v_mov_b32 v11, 0xffff
    v_lshlrev_b32 v11, v10, v11
    v_bfe_u32 v10, v1, 1, 2
    v_cmp_eq_u32 vcc, 0, v10
    s_nop 1
    v_cndmask_b32 v196, 0, v11, vcc
    v_cmp_eq_u32 vcc, 1, v10
    s_nop 1
    v_cndmask_b32 v197, 0, v11, vcc
    v_cmp_eq_u32 vcc, 2, v10
    s_nop 1
    v_cndmask_b32 v198, 0, v11, vcc
    v_cmp_eq_u32 vcc, 3, v10
    s_nop 1
    v_cndmask_b32 v199, 0, v11, vcc
    v_lshrrev_b32 v7, 3, v1
    v_lshlrev_b32 v7, 9, v7
    v_lshl_add_u32 v7, v2, 4, v7
    s_lshl_b32 s63, s34, 11
    v_lshl_add_u32 v249, v3, 4, s63
    s_lshl_b32 s63, s34, 9
    v_lshl_add_u32 v23, v3, 3, s63
    s_lshl_b32 s63, s34, 10
    v_lshl_add_u32 v21, v3, 4, s63
    v_lshlrev_b32 v22, 3, v3
    s_lshl_b32 s55, s32, 5
    s_add_u32 s55, s55, s33
    s_lshl_b32 s55, s55, 11
    s_add_u32 s50, s55, 131072
    s_add_u32 s51, s55, 1310720
    s_waitcnt lgkmcnt(0)
    s_add_u32 s28, s28, 1
    s_add_u32 s29, s29, 1
    s_add_u32 s30, s30, 1
    s_add_u32 s31, s31, 1
    s_and_b32 s63, s28, 0xfff
    v_mov_b32 v200, s63
    s_lshr_b32 s63, s29, 12
    s_xor_b32 s63, s63, s29
    s_and_b32 s63, s63, 0xfff
    v_mov_b32 v201, s63
    s_and_b32 s63, s30, 0xfff
    v_mov_b32 v202, s63
    s_lshr_b32 s63, s31, 20
    s_xor_b32 s63, s63, s31
    s_and_b32 s63, s63, 0xfff
    v_mov_b32 v203, s63
    v_mov_b32 v205, s31
    s_and_b32 s63, s30, 0xff
    v_mov_b32 v206, s63
    v_mov_b32 v31, v205
    v_mov_b32 v6, 0
    v_mov_b32 v29, 1
    ds_write_b32 v6, v6 offset:3072
    ds_write_b32 v6, v6 offset:3076
    s_mov_b32 s62, 200000
    s_getreg_b32 s99, hwreg(HW_REG_XCC_ID)
    s_and_b32 s99, s99, 15
    s_lshl_b32 s52, s32, 13
    s_add_u32 s52, s52, 65536
    v_and_b32 v8, 31, v3
    s_lshl_b32 s63, s34, 5
    v_add_u32 v8, s63, v8
    v_lshrrev_b32 v9, 5, v3
    v_lshlrev_b32 v9, 12, v9
    v_lshl_add_u32 v24, v8, 4, v9
    v_and_b32 v9, 7, v8
    v_sub_u32 v8, v8, v9
    v_lshl_add_u32 v8, v8, 2, v9
    v_lshlrev_b32 v26, 1, v8
    v_lshlrev_b32 v25, 7, v1
    v_lshl_add_u32 v25, v2, 4, v25
    v_add_u32 v25, s49, v25
    s_mov_b32 s3, 0
    s_sub_u32 s1, s62, 32
    s_waitcnt lgkmcnt(0)
    s_setprio 3
    s_barrier
    s_add_u32 m0, s49, 6784
    s_nop 0
    buffer_load_dwordx4 v4, s[40:43], s54 offen offset:384 nt lds
    buffer_load_dwordx4 v[64:67], v5, s[44:47], s48 offen offset:0 nt
    buffer_load_dwordx4 v[68:71], v5, s[44:47], s48 offen offset:256 nt
    buffer_load_dwordx4 v[72:75], v5, s[44:47], s48 offen offset:512 nt
    buffer_load_dwordx4 v[76:79], v5, s[44:47], s48 offen offset:768 nt
    s_add_u32 s53, s52, s3
    s_cmp_eq_u32 s3, 0
    s_cselect_b32 s98, s99, 0
    s_cselect_b32 s0, 0, 1
    v_xor_b32 v27, s98, v200
    buffer_load_dwordx4 v[128:131], v24, s[36:39], s53 offen offset:0 sc1
    buffer_load_dwordx4 v[132:135], v24, s[36:39], s53 offen offset:2048 sc1
    s_setprio 1
    buffer_load_dwordx4 v[80:83], v5, s[44:47], s48 offen offset:1024 nt
    buffer_load_dwordx4 v[84:87], v5, s[44:47], s48 offen offset:1280 nt
    buffer_load_dwordx4 v[88:91], v5, s[44:47], s48 offen offset:1536 nt
    s_add_u32 s53, s52, s3
    s_cmp_eq_u32 s3, 0
    s_cselect_b32 s98, s99, 0
    s_cselect_b32 s0, 0, 1
    v_xor_b32 v27, s98, v200
    buffer_load_dwordx4 v[136:139], v24, s[36:39], s53 offen offset:0 sc1
    buffer_load_dwordx4 v[140:143], v24, s[36:39], s53 offen offset:2048 sc1
    s_setprio 0
    buffer_load_dwordx4 v[92:95], v5, s[44:47], s48 offen offset:1792 nt
    s_waitcnt vmcnt(12)
    ds_read_b128 v[32:35], v25 offset:0
    ds_read_b128 v[36:39], v25 offset:64
    ds_read_b128 v[40:43], v25 offset:2048
    ds_read_b128 v[44:47], v25 offset:2112
    ds_read_b128 v[48:51], v25 offset:4096
    ds_read_b128 v[52:55], v25 offset:4160
    ds_read_b128 v[56:59], v25 offset:6144
    ds_read_b128 v[60:63], v25 offset:6208
    s_waitcnt vmcnt(6)
    v_xor_b32 v12, v128, v27
    v_xor_b32 v13, v129, v201
    v_xor_b32 v14, v130, v202
    v_xor_b32 v15, v131, v203
    v_xor_b32 v16, v132, v27
    v_xor_b32 v17, v133, v201
    v_xor_b32 v18, v134, v202
    v_xor_b32 v19, v135, v203
    v_or3_b32 v144, v12, v13, v14
    v_or3_b32 v145, v15, v16, v17
    v_or3_b32 v144, v144, v18, v19
    v_or_b32 v144, v144, v145
    v_and_b32 v144, 0x3ff, v144
    v_cmp_ne_u32 vcc, 0, v144
    s_nop 0
    s_cbranch_vccz L_e1ok
    s_waitcnt vmcnt(1)
    v_xor_b32 v12, v136, v27
    v_xor_b32 v13, v137, v201
    v_xor_b32 v14, v138, v202
    v_xor_b32 v15, v139, v203
    v_xor_b32 v16, v140, v27
    v_xor_b32 v17, v141, v201
    v_xor_b32 v18, v142, v202
    v_xor_b32 v19, v143, v203
    v_or3_b32 v144, v12, v13, v14
    v_or3_b32 v145, v15, v16, v17
    v_or3_b32 v144, v144, v18, v19
    v_or_b32 v144, v144, v145
    v_and_b32 v144, 0x3ff, v144
    v_cmp_ne_u32 vcc, 0, v144
    s_nop 0
    s_cbranch_vccz L_e1ok
L_e1poll:
    s_sub_u32 s62, s62, 1
    s_cbranch_scc1 L_end
    s_xor_b32 s63, s3, 1179648
    s_cmp_lt_u32 s62, s1
    s_cselect_b32 s3, s63, s3
    s_add_u32 s53, s52, s3
    s_cmp_eq_u32 s3, 0
    s_cselect_b32 s98, s99, 0
    s_cselect_b32 s0, 0, 1
    v_xor_b32 v27, s98, v200
    buffer_load_dwordx4 v[128:131], v24, s[36:39], s53 offen offset:0 sc1
    buffer_load_dwordx4 v[132:135], v24, s[36:39], s53 offen offset:2048 sc1
    s_waitcnt vmcnt(0)
    v_xor_b32 v12, v128, v27
    v_xor_b32 v13, v129, v201
    v_xor_b32 v14, v130, v202
    v_xor_b32 v15, v131, v203
    v_xor_b32 v16, v132, v27
    v_xor_b32 v17, v133, v201
    v_xor_b32 v18, v134, v202
    v_xor_b32 v19, v135, v203
    v_or3_b32 v144, v12, v13, v14
    v_or3_b32 v145, v15, v16, v17
    v_or3_b32 v144, v144, v18, v19
    v_or_b32 v144, v144, v145
    v_and_b32 v144, 0x3ff, v144
    v_cmp_ne_u32 vcc, 0, v144
    s_nop 0
    s_cbranch_vccz L_e1ok
    s_branch L_e1poll
L_e1ok:
    v_pk_add_f32 v[12:13], v[12:13], v[16:17]
    v_pk_add_f32 v[14:15], v[14:15], v[18:19]
    v_pk_mov_b32 v[16:17], v[12:13], v[12:13] op_sel:[0,1]
    v_pk_mov_b32 v[18:19], v[14:15], v[14:15] op_sel:[0,1]
    s_nop 0
    v_permlane32_swap_b32 v12, v16
    v_permlane32_swap_b32 v13, v17
    v_permlane32_swap_b32 v14, v18
    v_permlane32_swap_b32 v15, v19
    v_pk_add_f32 v[12:13], v[12:13], v[16:17]
    v_pk_add_f32 v[14:15], v[14:15], v[18:19]
    v_cvt_pk_bf16_f32 v8, v12, v13
    v_cvt_pk_bf16_f32 v9, v14, v15
    s_mov_b32 exec_hi, 0
    ds_write_b16 v26, v8 offset:0
    ds_write_b16_d16_hi v26, v8 offset:16
    ds_write_b16 v26, v9 offset:32
    ds_write_b16_d16_hi v26, v9 offset:48
    s_mov_b64 exec, -1
    s_cmp_eq_u32 s0, 0
    s_cbranch_scc1 L_fastq
    ds_write_b32 v6, v29 offset:3076
L_fastq:
    s_waitcnt lgkmcnt(0)
    s_setprio 2
    s_barrier
    ds_read_b128 v[96:99], v7 offset:0
    ds_read_b128 v[100:103], v7 offset:64
    ds_read_b128 v[104:107], v7 offset:128
    ds_read_b128 v[108:111], v7 offset:192
    ds_read_b128 v[112:115], v7 offset:256
    ds_read_b128 v[116:119], v7 offset:320
    ds_read_b128 v[120:123], v7 offset:384
    ds_read_b128 v[124:127], v7 offset:448
    s_mov_b32 s63, 0x3db8aa3b
    s_waitcnt lgkmcnt(7)
    v_mfma_f32_16x16x32_bf16 v[216:219], v[32:35], v[96:99], 0
    s_waitcnt lgkmcnt(6)
    v_mfma_f32_16x16x32_bf16 v[216:219], v[36:39], v[100:103], v[216:219]
    s_waitcnt lgkmcnt(5)
    v_mfma_f32_16x16x32_bf16 v[216:219], v[40:43], v[104:107], v[216:219]
    s_waitcnt lgkmcnt(4)
    v_mfma_f32_16x16x32_bf16 v[216:219], v[44:47], v[108:111], v[216:219]
    s_waitcnt lgkmcnt(3)
    v_mfma_f32_16x16x32_bf16 v[216:219], v[48:51], v[112:115], v[216:219]
    s_waitcnt lgkmcnt(2)
    v_mfma_f32_16x16x32_bf16 v[216:219], v[52:55], v[116:119], v[216:219]
    s_waitcnt lgkmcnt(1)
    v_mfma_f32_16x16x32_bf16 v[216:219], v[56:59], v[120:123], v[216:219]
    s_waitcnt lgkmcnt(0)
    v_mfma_f32_16x16x32_bf16 v[216:219], v[60:63], v[124:127], v[216:219]
    s_nop 7
    v_cvt_pk_bf16_f32 v8, v216, v217
    v_cvt_pk_bf16_f32 v9, v218, v219
    v_lshlrev_b32 v10, 16, v8
    v_and_b32 v11, 0xffff0000, v8
    v_lshlrev_b32 v12, 16, v9
    v_and_b32 v13, 0xffff0000, v9
    v_max3_f32 v14, v10, v11, v12
    v_max_f32 v14, v14, v13
    v_mov_b32 v15, v14
    s_nop 1
    v_permlane16_swap_b32 v14, v15
    v_max_f32 v14, v14, v15
    v_mov_b32 v15, v14
    s_nop 1
    v_permlane32_swap_b32 v14, v15
    v_max_f32 v14, v14, v15
    v_mul_f32 v14, s63, v14
    v_fma_f32 v10, v10, s63, -v14
    v_fma_f32 v11, v11, s63, -v14
    v_fma_f32 v12, v12, s63, -v14
    v_fma_f32 v13, v13, s63, -v14
    v_exp_f32 v10, v10
    v_exp_f32 v11, v11
    v_exp_f32 v12, v12
    v_exp_f32 v13, v13
    v_cvt_pk_bf16_f32 v16, v10, v10
    v_cvt_pk_bf16_f32 v17, v11, v11
    v_cvt_pk_bf16_f32 v18, v12, v12
    v_cvt_pk_bf16_f32 v19, v13, v13
    v_and_b32 v96, v16, v196
    v_and_b32 v97, v16, v197
    v_and_b32 v98, v16, v198
    v_and_b32 v99, v16, v199
    v_and_b32 v100, v17, v196
    v_and_b32 v101, v17, v197
    v_and_b32 v102, v17, v198
    v_and_b32 v103, v17, v199
    s_waitcnt vmcnt(10)
    v_mfma_f32_16x16x32_bf16 v[220:223], v[64:67], v[96:99], 0
    v_mfma_f32_16x16x32_bf16 v[224:227], v[68:71], v[96:99], 0
    v_and_b32 v104, v18, v196
    v_and_b32 v105, v18, v197
    v_and_b32 v106, v18, v198
    v_and_b32 v107, v18, v199
    v_add_f32 v15, v10, v11
    v_add_f32 v20, v12, v13
    s_waitcnt vmcnt(8)
    v_mfma_f32_16x16x32_bf16 v[220:223], v[72:75], v[100:103], v[220:223]
    v_mfma_f32_16x16x32_bf16 v[224:227], v[76:79], v[100:103], v[224:227]
    v_and_b32 v108, v19, v196
    v_and_b32 v109, v19, v197
    v_and_b32 v110, v19, v198
    v_and_b32 v111, v19, v199
    v_add_f32 v15, v15, v20
    s_waitcnt vmcnt(4)
    v_mfma_f32_16x16x32_bf16 v[220:223], v[80:83], v[104:107], v[220:223]
    v_mfma_f32_16x16x32_bf16 v[224:227], v[84:87], v[104:107], v[224:227]
    v_mov_b32 v20, v15
    s_nop 1
    v_permlane16_swap_b32 v15, v20
    v_add_f32 v15, v15, v20
    s_waitcnt vmcnt(0)
    v_mfma_f32_16x16x32_bf16 v[220:223], v[88:91], v[108:111], v[220:223]
    v_mfma_f32_16x16x32_bf16 v[224:227], v[92:95], v[108:111], v[224:227]
    v_mov_b32 v20, v15
    s_nop 1
    v_permlane32_swap_b32 v15, v20
    v_add_f32 v15, v15, v20
    ds_write_b64 v23, v[14:15] offset:1024
    s_nop 0
    ds_write_b128 v249, v[220:223] offset:4096
    ds_write_b128 v249, v[224:227] offset:5120
    s_mov_b32 exec_lo, 0x00000001
    s_mov_b32 exec_hi, 0x00000000
    ds_add_u32 v6, v29 offset:3072
    s_mov_b64 exec, -1
    s_cmp_ge_u32 s34, 2
    s_cbranch_scc1 L_att_exit
L_cnt:
    ds_read_b32 v8, v6 offset:3072
    s_sub_u32 s62, s62, 1
    s_cbranch_scc1 L_end
    s_waitcnt lgkmcnt(0)
    v_cmp_gt_u32 vcc, 4, v8
    s_nop 0
    s_cbranch_vccnz L_cnt
    ds_read_b64 v[10:11], v22 offset:1024
    ds_read_b64 v[12:13], v22 offset:1536
    ds_read_b64 v[14:15], v22 offset:2048
    ds_read_b64 v[16:17], v22 offset:2560
    ds_read_b128 v[232:235], v21 offset:4096
    ds_read_b128 v[236:239], v21 offset:6144
    ds_read_b128 v[240:243], v21 offset:8192
    ds_read_b128 v[244:247], v21 offset:10240
    s_movk_i32 s63, 0xff
    s_waitcnt lgkmcnt(4)
    v_max3_f32 v18, v10, v12, v14
    v_max_f32 v18, v18, v16
    v_sub_f32 v10, v10, v18
    v_sub_f32 v12, v12, v18
    v_sub_f32 v14, v14, v18
    v_sub_f32 v16, v16, v18
    v_exp_f32 v10, v10
    v_exp_f32 v12, v12
    v_exp_f32 v14, v14
    v_exp_f32 v16, v16
    v_mul_f32 v19, v10, v11
    v_fmac_f32 v19, v12, v13
    v_fmac_f32 v19, v14, v15
    v_fmac_f32 v19, v16, v17
    v_rcp_f32 v20, v19
    v_log_f32 v9, v19
    s_waitcnt lgkmcnt(0)
    v_pk_mul_f32 v[24:25], v[10:11], v[232:233] op_sel_hi:[0,1]
    v_pk_mul_f32 v[26:27], v[10:11], v[234:235] op_sel_hi:[0,1]
    v_pk_fma_f32 v[24:25], v[12:13], v[236:237], v[24:25] op_sel_hi:[0,1,1]
    v_pk_fma_f32 v[26:27], v[12:13], v[238:239], v[26:27] op_sel_hi:[0,1,1]
    v_pk_fma_f32 v[24:25], v[14:15], v[240:241], v[24:25] op_sel_hi:[0,1,1]
    v_pk_fma_f32 v[26:27], v[14:15], v[242:243], v[26:27] op_sel_hi:[0,1,1]
    v_pk_fma_f32 v[24:25], v[16:17], v[244:245], v[24:25] op_sel_hi:[0,1,1]
    v_pk_fma_f32 v[26:27], v[16:17], v[246:247], v[26:27] op_sel_hi:[0,1,1]
    v_add_f32 v9, v9, v18
    v_pk_mul_f32 v[24:25], v[20:21], v[24:25] op_sel_hi:[0,1]
    v_pk_mul_f32 v[26:27], v[20:21], v[26:27] op_sel_hi:[0,1]
    v_bfi_b32 v30, s63, v206, v9
    v_cvt_pk_bf16_f32 v28, v24, v25
    v_cvt_pk_bf16_f32 v29, v26, v27
    buffer_store_dwordx4 v[28:31], v21, s[36:39], s50 offen
    v_mov_b32 v8, 1
    s_mov_b32 exec_lo, 0x00000001
    s_mov_b32 exec_hi, 0x00000000
    ds_add_u32 v6, v8 offset:3072
    s_mov_b64 exec, -1
    v_mov_b32 v8, 0
    ds_read_b32 v8, v8 offset:3076
    s_waitcnt lgkmcnt(0)
    v_cmp_eq_u32 vcc, 0, v8
    s_nop 0
    s_cbranch_vccnz L_end
    buffer_store_dwordx4 v[28:31], v21, s[36:39], s51 offen sc1
    s_nop 0
    s_branch L_end
L_att_exit:
    s_branch L_end
L_tail:
    s_cmp_lg_u32 s34, 4
    s_cbranch_scc1 L_tail_common
    v_lshrrev_b32 v4, 3, v1
    v_mul_u32_u24 v4, 56, v4
    v_mul_u32_u24 v5, 14, v2
    v_add_u32 v4, v4, v5
    v_lshlrev_b32 v5, 13, v4
    v_and_b32 v6, 7, v1
    v_lshl_add_u32 v5, v6, 4, v5
    v_lshlrev_b32 v4, 1, v4
    v_lshlrev_b32 v6, 4, v3
    s_lshr_b32 s50, s33, 3
    s_mul_i32 s52, s50, 917504
    s_lshl_b32 s53, s32, 10
    s_add_u32 s52, s52, s53
    s_and_b32 s53, s33, 7
    s_lshl_b32 s53, s53, 7
    s_add_u32 s52, s52, s53
    s_mul_i32 s51, s50, 224
    s_mov_b32 s42, 3670016
    s_mov_b32 s43, 0x20000
    s_mov_b32 s46, 896
    s_mov_b32 s47, 0x20000
    s_setprio 3
    s_waitcnt lgkmcnt(0)
    s_mov_b32 s44, s4
    s_and_b32 s45, s5, 0xffff
    s_mov_b32 s40, s10
    s_and_b32 s41, s11, 0xffff
    buffer_load_dwordx4 v[232:235], v6, s[44:47], 0 offen
    buffer_load_dwordx4 v[144:147], v4, s[44:47], s51 offen
    buffer_load_dwordx3 v[148:150], v4, s[44:47], s51 offen offset:16
    buffer_load_dwordx4 v[32:35], v5, s[40:43], s52 offen nt
    s_add_u32 s52, s52, 8192
    buffer_load_dwordx4 v[36:39], v5, s[40:43], s52 offen nt
    s_add_u32 s52, s52, 8192
    buffer_load_dwordx4 v[40:43], v5, s[40:43], s52 offen nt
    s_add_u32 s52, s52, 8192
    buffer_load_dwordx4 v[44:47], v5, s[40:43], s52 offen nt
    s_add_u32 s52, s52, 8192
    buffer_load_dwordx4 v[48:51], v5, s[40:43], s52 offen nt
    s_add_u32 s52, s52, 8192
    buffer_load_dwordx4 v[52:55], v5, s[40:43], s52 offen nt
    s_add_u32 s52, s52, 8192
    buffer_load_dwordx4 v[56:59], v5, s[40:43], s52 offen nt
    s_add_u32 s52, s52, 8192
    buffer_load_dwordx4 v[60:63], v5, s[40:43], s52 offen nt
    s_add_u32 s52, s52, 8192
    buffer_load_dwordx4 v[64:67], v5, s[40:43], s52 offen nt
    s_add_u32 s52, s52, 8192
    buffer_load_dwordx4 v[68:71], v5, s[40:43], s52 offen nt
    s_add_u32 s52, s52, 8192
    buffer_load_dwordx4 v[72:75], v5, s[40:43], s52 offen nt
    s_add_u32 s52, s52, 8192
    buffer_load_dwordx4 v[76:79], v5, s[40:43], s52 offen nt
    s_add_u32 s52, s52, 8192
    buffer_load_dwordx4 v[80:83], v5, s[40:43], s52 offen nt
    s_add_u32 s52, s52, 8192
    buffer_load_dwordx4 v[84:87], v5, s[40:43], s52 offen nt
L_tail_common:
    s_waitcnt lgkmcnt(0)
    s_barrier
    s_load_dwordx4 s[28:31], s[26:27], 0
    s_mov_b32 s36, s26
    s_and_b32 s37, s27, 0xffff
    s_mov_b32 s38, 4194304
    s_mov_b32 s39, 0x20000
    s_mov_b32 s62, 200000
    s_getreg_b32 s99, hwreg(HW_REG_XCC_ID)
    s_and_b32 s99, s99, 15
    s_mov_b32 s56, 0xaaaaaaaa
    s_mov_b32 s57, 0xaaaaaaaa
    s_mov_b32 s58, 0xf0f0f0f0
    s_mov_b32 s59, 0xf0f0f0f0
    s_mov_b32 s96, 0xff00ff00
    s_mov_b32 s97, 0xff00ff00
    s_mov_b32 s60, 0x00000000
    s_mov_b32 s61, 0xffffffff
    v_mov_b32 v207, 1.0
    v_lshrrev_b32 v8, 2, v3
    v_lshlrev_b32 v8, 11, v8
    v_and_b32 v9, 3, v3
    v_lshl_add_u32 v213, v9, 4, v8
    v_and_b32 v10, 1, v1
    v_lshlrev_b32 v10, 4, v10
    v_mov_b32 v11, 0xffff
    v_lshlrev_b32 v11, v10, v11
    v_bfe_u32 v10, v1, 1, 2
    v_cmp_eq_u32 vcc, 0, v10
    s_nop 1
    v_cndmask_b32 v196, 0, v11, vcc
    v_cmp_eq_u32 vcc, 1, v10
    s_nop 1
    v_cndmask_b32 v197, 0, v11, vcc
    v_cmp_eq_u32 vcc, 2, v10
    s_nop 1
    v_cndmask_b32 v198, 0, v11, vcc
    v_cmp_eq_u32 vcc, 3, v10
    s_nop 1
    v_cndmask_b32 v199, 0, v11, vcc
    v_lshl_add_u32 v8, v2, 3, v1
    v_lshlrev_b32 v214, 4, v8
    s_lshl_b32 s52, s32, 13
    s_add_u32 s52, s52, 65536
    s_lshl_b32 s53, s33, 8
    s_add_u32 s53, s53, s52
    s_cmp_lg_u32 s34, 4
    s_cbranch_scc1 L_notq
    s_add_u32 s49, s53, 1179648
    s_waitcnt vmcnt(14)
    v_lshlrev_b32 v152, 16, v232
    v_and_b32 v153, 0xffff0000, v232
    v_lshlrev_b32 v154, 16, v233
    v_and_b32 v155, 0xffff0000, v233
    v_lshlrev_b32 v156, 16, v234
    v_and_b32 v157, 0xffff0000, v234
    v_lshlrev_b32 v158, 16, v235
    v_and_b32 v159, 0xffff0000, v235
    v_readlane_b32 s63, v152, 0
    v_mov_b32 v16, 0
    v_mov_b32 v17, 0
    s_mov_b32 exec_lo, 0xffffffff
    s_mov_b32 exec_hi, 0x00ffffff
    v_subrev_f32 v8, s63, v152
    v_subrev_f32 v9, s63, v153
    v_subrev_f32 v10, s63, v154
    v_subrev_f32 v11, s63, v155
    v_subrev_f32 v12, s63, v156
    v_subrev_f32 v13, s63, v157
    v_subrev_f32 v14, s63, v158
    v_subrev_f32 v15, s63, v159
    v_add_f32 v16, v8, v9
    v_mul_f32 v17, v8, v8
    v_add_f32 v18, v10, v11
    v_mul_f32 v19, v9, v9
    v_add_f32 v16, v16, v12
    v_add_f32 v18, v18, v13
    v_add_f32 v16, v16, v14
    v_add_f32 v18, v18, v15
    v_fmac_f32 v17, v10, v10
    v_fmac_f32 v19, v11, v11
    v_fmac_f32 v17, v12, v12
    v_fmac_f32 v19, v13, v13
    v_fmac_f32 v17, v14, v14
    v_fmac_f32 v19, v15, v15
    v_add_f32 v16, v16, v18
    v_add_f32 v17, v17, v19
    s_mov_b64 exec, -1
    v_add_f32_dpp v16, v16, v16 row_ror:8 row_mask:0xf bank_mask:0xf
    v_add_f32_dpp v17, v17, v17 row_ror:8 row_mask:0xf bank_mask:0xf
    v_lshlrev_b32 v160, 16, v144
    v_add_f32_dpp v16, v16, v16 row_ror:4 row_mask:0xf bank_mask:0xf
    v_add_f32_dpp v17, v17, v17 row_ror:4 row_mask:0xf bank_mask:0xf
    v_and_b32 v161, 0xffff0000, v144
    v_add_f32_dpp v16, v16, v16 row_ror:2 row_mask:0xf bank_mask:0xf
    v_add_f32_dpp v17, v17, v17 row_ror:2 row_mask:0xf bank_mask:0xf
    v_lshlrev_b32 v162, 16, v145
    v_add_f32_dpp v16, v16, v16 row_ror:1 row_mask:0xf bank_mask:0xf
    v_add_f32_dpp v17, v17, v17 row_ror:1 row_mask:0xf bank_mask:0xf
    v_and_b32 v163, 0xffff0000, v145
    v_mov_b32 v18, v16
    v_mov_b32 v19, v17
    v_lshlrev_b32 v164, 16, v146
    v_permlane16_swap_b32 v16, v18
    v_permlane16_swap_b32 v17, v19
    v_add_f32 v16, v16, v18
    v_add_f32 v17, v17, v19
    v_mov_b32 v18, v16
    v_mov_b32 v19, v17
    v_and_b32 v165, 0xffff0000, v146
    v_permlane32_swap_b32 v16, v18
    v_permlane32_swap_b32 v17, v19
    v_add_f32 v16, v16, v18
    v_add_f32 v17, v17, v19
    v_mul_f32 v16, 0x3b124925, v16
    v_mul_f32 v17, 0x3b124925, v17
    v_fma_f32 v17, -v16, v16, v17
    v_add_f32 v16, s63, v16
    v_max_f32 v17, 0, v17
    v_cvt_pk_bf16_f32 v18, v16, v17
    v_and_b32 v17, 0xffff0000, v18
    v_lshlrev_b32 v16, 16, v18
    v_add_f32 v17, 0x3727c5ac, v17
    v_cvt_pk_bf16_f32 v17, v17, v17
    v_and_b32 v17, 0xffff0000, v17
    v_sqrt_f32 v17, v17
    v_lshlrev_b32 v166, 16, v147
    v_and_b32 v167, 0xffff0000, v147
    v_lshlrev_b32 v168, 16, v148
    v_and_b32 v169, 0xffff0000, v148
    v_lshlrev_b32 v170, 16, v149
    v_and_b32 v171, 0xffff0000, v149
    v_lshlrev_b32 v172, 16, v150
    v_and_b32 v173, 0xffff0000, v150
    v_sub_f32 v176, v160, v16
    v_sub_f32 v177, v161, v16
    v_sub_f32 v178, v162, v16
    v_sub_f32 v179, v163, v16
    v_sub_f32 v180, v164, v16
    v_sub_f32 v181, v165, v16
    v_sub_f32 v182, v166, v16
    v_sub_f32 v183, v167, v16
    v_sub_f32 v184, v168, v16
    v_sub_f32 v185, v169, v16
    v_sub_f32 v186, v170, v16
    v_sub_f32 v187, v171, v16
    v_sub_f32 v188, v172, v16
    v_sub_f32 v189, v173, v16
    v_cvt_pk_bf16_f32 v17, v17, v17
    v_and_b32 v17, 0xffff0000, v17
    v_rcp_f32 v17, v17
    v_cvt_pk_bf16_f32 v216, v176, v177
    v_cvt_pk_bf16_f32 v217, v178, v179
    v_cvt_pk_bf16_f32 v218, v180, v181
    v_cvt_pk_bf16_f32 v219, v182, v183
    v_cvt_pk_bf16_f32 v220, v184, v185
    v_cvt_pk_bf16_f32 v221, v186, v187
    v_cvt_pk_bf16_f32 v222, v188, v189
    v_lshlrev_b32 v176, 16, v216
    v_and_b32 v177, 0xffff0000, v216
    v_lshlrev_b32 v178, 16, v217
    v_and_b32 v179, 0xffff0000, v217
    v_lshlrev_b32 v180, 16, v218
    v_and_b32 v181, 0xffff0000, v218
    v_lshlrev_b32 v182, 16, v219
    v_and_b32 v183, 0xffff0000, v219
    v_lshlrev_b32 v184, 16, v220
    v_and_b32 v185, 0xffff0000, v220
    v_lshlrev_b32 v186, 16, v221
    v_and_b32 v187, 0xffff0000, v221
    v_lshlrev_b32 v188, 16, v222
    v_and_b32 v189, 0xffff0000, v222
    v_mul_f32 v176, v176, v17
    v_mul_f32 v177, v177, v17
    v_mul_f32 v178, v178, v17
    v_mul_f32 v179, v179, v17
    v_mul_f32 v180, v180, v17
    v_mul_f32 v181, v181, v17
    v_mul_f32 v182, v182, v17
    v_mul_f32 v183, v183, v17
    v_mul_f32 v184, v184, v17
    v_mul_f32 v185, v185, v17
    v_mul_f32 v186, v186, v17
    v_mul_f32 v187, v187, v17
    v_mul_f32 v188, v188, v17
    v_mul_f32 v189, v189, v17
    v_cvt_pk_bf16_f32 v176, v176, v176
    v_cvt_pk_bf16_f32 v177, v177, v177
    v_cvt_pk_bf16_f32 v178, v178, v178
    v_cvt_pk_bf16_f32 v179, v179, v179
    v_cvt_pk_bf16_f32 v180, v180, v180
    v_cvt_pk_bf16_f32 v181, v181, v181
    v_cvt_pk_bf16_f32 v182, v182, v182
    v_cvt_pk_bf16_f32 v183, v183, v183
    v_cvt_pk_bf16_f32 v184, v184, v184
    v_cvt_pk_bf16_f32 v185, v185, v185
    v_cvt_pk_bf16_f32 v186, v186, v186
    v_cvt_pk_bf16_f32 v187, v187, v187
    v_cvt_pk_bf16_f32 v188, v188, v188
    v_cvt_pk_bf16_f32 v189, v189, v189
    s_waitcnt lgkmcnt(0)
    s_add_u32 s28, s28, 1
    s_add_u32 s29, s29, 1
    s_add_u32 s30, s30, 1
    s_add_u32 s31, s31, 1
    s_and_b32 s63, s28, 0xfff
    v_mov_b32 v200, s63
    s_lshr_b32 s63, s29, 12
    s_xor_b32 s63, s63, s29
    s_and_b32 s63, s63, 0xfff
    v_mov_b32 v201, s63
    s_and_b32 s63, s30, 0xfff
    v_mov_b32 v202, s63
    s_lshr_b32 s63, s31, 20
    s_xor_b32 s63, s63, s31
    s_and_b32 s63, s63, 0xfff
    v_mov_b32 v203, s63
    v_mov_b32 v205, s31
    s_and_b32 s63, s30, 0xff
    v_mov_b32 v206, s63
    v_and_b32 v88, v176, v196
    v_and_b32 v89, v176, v197
    v_and_b32 v90, v176, v198
    v_and_b32 v91, v176, v199
    v_and_b32 v92, v177, v196
    v_and_b32 v93, v177, v197
    v_and_b32 v94, v177, v198
    v_and_b32 v95, v177, v199
    s_waitcnt vmcnt(13)
    v_mfma_f32_16x16x32_bf16 v[216:219], v[32:35], v[88:91], 0
    v_and_b32 v96, v178, v196
    v_and_b32 v97, v178, v197
    v_and_b32 v98, v178, v198
    v_and_b32 v99, v178, v199
    s_waitcnt vmcnt(12)
    v_mfma_f32_16x16x32_bf16 v[216:219], v[36:39], v[92:95], v[216:219]
    v_and_b32 v100, v179, v196
    v_and_b32 v101, v179, v197
    v_and_b32 v102, v179, v198
    v_and_b32 v103, v179, v199
    s_waitcnt vmcnt(11)
    v_mfma_f32_16x16x32_bf16 v[216:219], v[40:43], v[96:99], v[216:219]
    v_and_b32 v104, v180, v196
    v_and_b32 v105, v180, v197
    v_and_b32 v106, v180, v198
    v_and_b32 v107, v180, v199
    s_waitcnt vmcnt(10)
    v_mfma_f32_16x16x32_bf16 v[216:219], v[44:47], v[100:103], v[216:219]
    v_and_b32 v108, v181, v196
    v_and_b32 v109, v181, v197
    v_and_b32 v110, v181, v198
    v_and_b32 v111, v181, v199
    s_waitcnt vmcnt(9)
    v_mfma_f32_16x16x32_bf16 v[216:219], v[48:51], v[104:107], v[216:219]
    v_and_b32 v112, v182, v196
    v_and_b32 v113, v182, v197
    v_and_b32 v114, v182, v198
    v_and_b32 v115, v182, v199
    s_waitcnt vmcnt(8)
    v_mfma_f32_16x16x32_bf16 v[216:219], v[52:55], v[108:111], v[216:219]
    v_and_b32 v116, v183, v196
    v_and_b32 v117, v183, v197
    v_and_b32 v118, v183, v198
    v_and_b32 v119, v183, v199
    s_waitcnt vmcnt(7)
    v_mfma_f32_16x16x32_bf16 v[216:219], v[56:59], v[112:115], v[216:219]
    v_and_b32 v120, v184, v196
    v_and_b32 v121, v184, v197
    v_and_b32 v122, v184, v198
    v_and_b32 v123, v184, v199
    s_waitcnt vmcnt(6)
    v_mfma_f32_16x16x32_bf16 v[216:219], v[60:63], v[116:119], v[216:219]
    v_and_b32 v124, v185, v196
    v_and_b32 v125, v185, v197
    v_and_b32 v126, v185, v198
    v_and_b32 v127, v185, v199
    s_waitcnt vmcnt(5)
    v_mfma_f32_16x16x32_bf16 v[216:219], v[64:67], v[120:123], v[216:219]
    v_and_b32 v128, v186, v196
    v_and_b32 v129, v186, v197
    v_and_b32 v130, v186, v198
    v_and_b32 v131, v186, v199
    s_waitcnt vmcnt(4)
    v_mfma_f32_16x16x32_bf16 v[216:219], v[68:71], v[124:127], v[216:219]
    v_and_b32 v132, v187, v196
    v_and_b32 v133, v187, v197
    v_and_b32 v134, v187, v198
    v_and_b32 v135, v187, v199
    s_waitcnt vmcnt(3)
    v_mfma_f32_16x16x32_bf16 v[216:219], v[72:75], v[128:131], v[216:219]
    v_and_b32 v136, v188, v196
    v_and_b32 v137, v188, v197
    v_and_b32 v138, v188, v198
    v_and_b32 v139, v188, v199
    s_waitcnt vmcnt(2)
    v_mfma_f32_16x16x32_bf16 v[216:219], v[76:79], v[132:135], v[216:219]
    v_and_b32 v140, v189, v196
    v_and_b32 v141, v189, v197
    v_and_b32 v142, v189, v198
    v_and_b32 v143, v189, v199
    s_waitcnt vmcnt(1)
    v_mfma_f32_16x16x32_bf16 v[216:219], v[80:83], v[136:139], v[216:219]
    s_waitcnt vmcnt(0)
    v_mfma_f32_16x16x32_bf16 v[216:219], v[84:87], v[140:143], v[216:219]
    s_movk_i32 s63, 0xfff
    s_nop 6
    v_mov_b32_dpp v8, v216 row_ror:8 row_mask:0xf bank_mask:0xf
    v_mov_b32_dpp v9, v217 row_ror:8 row_mask:0xf bank_mask:0xf
    v_mov_b32_dpp v10, v218 row_ror:8 row_mask:0xf bank_mask:0xf
    v_mov_b32_dpp v11, v219 row_ror:8 row_mask:0xf bank_mask:0xf
    v_mov_b32 v12, v8
    v_mov_b32 v13, v9
    v_mov_b32 v14, v10
    v_mov_b32 v15, v11
    v_permlane32_swap_b32 v8, v12
    v_permlane32_swap_b32 v9, v13
    v_permlane32_swap_b32 v10, v14
    v_permlane32_swap_b32 v11, v15
    v_add_f32 v12, v12, v216
    v_add_f32 v13, v13, v217
    v_add_f32 v14, v14, v218
    v_add_f32 v15, v15, v219
    v_add_u32 v12, 0x200, v12
    v_add_u32 v13, 0x200, v13
    v_add_u32 v14, 0x200, v14
    v_add_u32 v15, 0x200, v15
    v_and_b32 v12, 0xfffffc00, v12
    v_and_b32 v13, 0xfffffc00, v13
    v_and_b32 v14, 0xfffffc00, v14
    v_and_b32 v15, 0xfffffc00, v15
    v_xor_b32 v28, v12, v200
    v_xor_b32 v29, v13, v201
    v_xor_b32 v30, v14, v202
    v_xor_b32 v31, v15, v203
    s_mov_b32 exec_lo, 0x00ff00ff
    s_mov_b32 exec_hi, 0x00000000
    v_xor_b32 v16, s99, v28
    v_mov_b32 v17, v29
    v_mov_b32 v18, v30
    v_mov_b32 v19, v31
    buffer_store_dwordx4 v[16:19], v214, s[36:39], s53 offen
    buffer_store_dwordx4 v[28:31], v214, s[36:39], s49 offen sc1
    s_mov_b64 exec, -1
    s_setprio 0
    s_branch L_e1
L_notq:
    s_waitcnt lgkmcnt(0)
    s_add_u32 s28, s28, 1
    s_add_u32 s29, s29, 1
    s_add_u32 s30, s30, 1
    s_add_u32 s31, s31, 1
    s_and_b32 s63, s28, 0xfff
    v_mov_b32 v200, s63
    s_lshr_b32 s63, s29, 12
    s_xor_b32 s63, s63, s29
    s_and_b32 s63, s63, 0xfff
    v_mov_b32 v201, s63
    s_and_b32 s63, s30, 0xfff
    v_mov_b32 v202, s63
    s_lshr_b32 s63, s31, 20
    s_xor_b32 s63, s63, s31
    s_and_b32 s63, s63, 0xfff
    v_mov_b32 v203, s63
    v_mov_b32 v205, s31
    s_and_b32 s63, s30, 0xff
    v_mov_b32 v206, s63
    s_cmp_lg_u32 s34, 7
    s_cbranch_scc1 L_nocpf
    s_cmp_lg_u32 s33, 31
    s_cbranch_scc1 L_nocpf
    s_getpc_b64 s[48:49]
L_pc:
    s_sub_u32 s48, s48, L_pc-sequential_preLN__sliding_block_cached__dense_activation_mish__decode_kernel
    s_subb_u32 s49, s49, 0
    v_lshlrev_b32 v8, 7, v3
    v_min_u32 v9, L_exit-sequential_preLN__sliding_block_cached__dense_activation_mish__decode_kernel-8192, v8
    global_load_dword v250, v8, s[48:49]
    v_add_u32 v9, 8192, v9
    global_load_dword v250, v9, s[48:49]
L_nocpf:
L_e1:
    s_barrier
    s_cmp_lg_u32 s34, 5
    s_cbranch_scc1 L_nopre2
    s_lshl_b32 s55, s32, 5
    s_add_u32 s55, s55, s33
    s_lshl_b32 s55, s55, 11
    s_add_u32 s63, s55, 131072
    v_lshlrev_b32 v8, 7, v3
    s_mov_b32 exec_lo, 0x0000ffff
    s_mov_b32 exec_hi, 0x00000000
    buffer_load_dword v250, v8, s[36:39], s63 offen sc1
    s_mov_b64 exec, -1
L_nopre2:
    s_cmp_lt_u32 s33, 30
    s_cbranch_scc1 L_roles
    s_barrier
    s_branch L_end
L_roles:
    s_cmp_ge_u32 s33, 23
    s_cbranch_scc1 L_R
    s_cmp_ge_u32 s33, 16
    s_cbranch_scc1 L_F
    s_lshl_b32 s48, s33, 1
    s_lshr_b32 s49, s35, 1
    s_add_u32 s48, s48, s49
    s_lshl_b32 s50, s32, 9
    s_bfe_u32 s49, s48, 0x10001
    s_lshl_b32 s49, s49, 8
    s_add_u32 s50, s50, s49
    s_lshr_b32 s49, s48, 4
    s_lshl_b32 s49, s49, 7
    s_add_u32 s50, s50, s49
    s_bfe_u32 s49, s48, 0x20002
    s_lshl_b32 s49, s49, 5
    s_add_u32 s50, s50, s49
    s_and_b32 s49, s48, 1
    s_lshl_b32 s49, s49, 2
    s_add_u32 s50, s50, s49
    s_mul_i32 s50, s50, 896
    s_and_b32 s49, s35, 1
    s_lshl_b32 s49, s49, 9
    s_add_u32 s50, s50, s49
    v_mul_u32_u24 v6, 7168, v2
    v_lshl_add_u32 v6, v1, 4, v6
    s_mov_b32 s40, s12
    s_and_b32 s41, s13, 0xffff
    s_mov_b32 s42, 3670016
    s_mov_b32 s43, 0x20000
    s_lshl_b32 s54, s32, 16
    s_lshl_b32 s63, s48, 6
    s_add_u32 s54, s54, s63
    s_lshl_b32 s55, s32, 5
    s_add_u32 s55, s55, s48
    s_lshl_b32 s55, s55, 11
    s_lshl_b32 s49, s49, 1
    s_add_u32 s55, s55, s49
    s_add_u32 s52, s55, 655360
    s_add_u32 s53, s55, 1835008
    v_cmp_lt_u32 s[6:7], 7, v1
    v_add_u32 v4, 384, v214
    s_nop 0
    v_cndmask_b32 v4, v214, v4, s[6:7]
    s_mov_b64 s[8:9], -1
    s_bitcmp1_b32 s35, 0
    s_cselect_b32 s9, 0x00ff00ff, s9
    s_mov_b32 s0, 0
    s_barrier
    buffer_load_dwordx4 v[32:35], v6, s[40:43], s50 offen offset:0 nt
    buffer_load_dwordx4 v[36:39], v6, s[40:43], s50 offen offset:896 nt
    buffer_load_dwordx4 v[40:43], v6, s[40:43], s50 offen offset:1792 nt
    buffer_load_dwordx4 v[44:47], v6, s[40:43], s50 offen offset:2688 nt
    s_mov_b32 exec_lo, s9
    s_mov_b32 exec_hi, s9
    buffer_load_dwordx4 v[48:51], v6, s[40:43], s50 offen offset:256 nt
    buffer_load_dwordx4 v[52:55], v6, s[40:43], s50 offen offset:1152 nt
    buffer_load_dwordx4 v[56:59], v6, s[40:43], s50 offen offset:2048 nt
    buffer_load_dwordx4 v[60:63], v6, s[40:43], s50 offen offset:2944 nt
    s_mov_b64 exec, -1
    v_mov_b32 v5, 0
L_wc_1:
    ds_read_b32 v7, v5 offset:3072
    s_sub_u32 s62, s62, 1
    s_cbranch_scc1 L_end
    s_sleep 1
    s_waitcnt lgkmcnt(0)
    v_cmp_gt_u32 vcc, 4, v7
    s_nop 0
    s_cbranch_vccnz L_wc_1
    s_mov_b32 s3, 0
    s_sub_u32 s1, s62, 64
    s_add_u32 s48, s54, s3
    s_add_u32 s49, s48, 163840
    s_add_u32 s48, s48, 131072
    buffer_load_dwordx4 v[112:115], v213, s[36:39], s48 offen sc1
    buffer_load_dwordx4 v[116:119], v213, s[36:39], s49 offen sc1
L_e2poll:
    s_waitcnt vmcnt(0)
    v_xor_b32 v10, v114, v206
    v_xor_b32 v11, v118, v206
    v_xor_b32 v12, v115, v205
    v_xor_b32 v13, v119, v205
    v_or_b32 v14, v10, v11
    v_and_b32 v14, 0xff, v14
    v_or3_b32 v14, v14, v12, v13
    v_cmp_ne_u32 vcc, 0, v14
    v_lshlrev_b32 v16, 16, v112
    v_and_b32 v17, 0xffff0000, v112
    v_lshlrev_b32 v18, 16, v113
    v_and_b32 v19, 0xffff0000, v113
    v_lshlrev_b32 v20, 16, v116
    v_and_b32 v21, 0xffff0000, v116
    v_lshlrev_b32 v22, 16, v117
    v_and_b32 v23, 0xffff0000, v117
    s_nop 0
    s_cbranch_vccz L_e2poll_ok
    s_sub_u32 s62, s62, 1
    s_cbranch_scc1 L_end
    s_xor_b32 s63, s3, 1179648
    s_cmp_lt_u32 s62, s1
    s_cselect_b32 s3, s63, s3
    s_add_u32 s48, s54, s3
    s_add_u32 s49, s48, 163840
    s_add_u32 s48, s48, 131072
    buffer_load_dwordx4 v[112:115], v213, s[36:39], s48 offen sc1
    buffer_load_dwordx4 v[116:119], v213, s[36:39], s49 offen sc1
    s_branch L_e2poll
L_e2poll_ok:
    v_max_f32 v14, v10, v11
    s_nop 1
    v_max_f32_dpp v14, v14, v14 row_ror:8 row_mask:0xf bank_mask:0xf
    s_nop 1
    v_max_f32_dpp v14, v14, v14 row_ror:4 row_mask:0xf bank_mask:0xf
    v_mov_b32 v15, v14
    s_nop 1
    v_permlane16_swap_b32 v14, v15
    v_max_f32 v14, v14, v15
    v_mov_b32 v15, v14
    s_nop 1
    v_permlane32_swap_b32 v14, v15
    v_max_f32 v14, v14, v15
    v_sub_f32 v10, v10, v14
    v_sub_f32 v11, v11, v14
    v_exp_f32 v10, v10
    v_exp_f32 v11, v11
    s_movk_i32 s63, 0xfff
    v_pk_mul_f32 v[16:17], v[10:11], v[16:17] op_sel_hi:[0,1]
    v_pk_mul_f32 v[18:19], v[10:11], v[18:19] op_sel_hi:[0,1]
    v_add_f32 v12, v10, v11
    v_pk_fma_f32 v[16:17], v[10:11], v[20:21], v[16:17] op_sel:[1,0,0] op_sel_hi:[1,1,1]
    v_pk_fma_f32 v[18:19], v[10:11], v[22:23], v[18:19] op_sel:[1,0,0] op_sel_hi:[1,1,1]
    v_add_f32_dpp v12, v12, v12 row_ror:8 row_mask:0xf bank_mask:0xf
    s_nop 1
    v_add_f32_dpp v12, v12, v12 row_ror:4 row_mask:0xf bank_mask:0xf
    s_nop 1
    v_mfma_f32_16x16x4_f32 v[220:223], v12, v207, 0
    v_add_f32_dpp v16, v16, v16 row_ror:8 row_mask:0xf bank_mask:0xf
    v_add_f32_dpp v17, v17, v17 row_ror:8 row_mask:0xf bank_mask:0xf
    v_add_f32_dpp v18, v18, v18 row_ror:8 row_mask:0xf bank_mask:0xf
    v_add_f32_dpp v19, v19, v19 row_ror:8 row_mask:0xf bank_mask:0xf
    v_add_f32_dpp v16, v16, v16 row_ror:4 row_mask:0xf bank_mask:0xf
    v_add_f32_dpp v17, v17, v17 row_ror:4 row_mask:0xf bank_mask:0xf
    v_add_f32_dpp v18, v18, v18 row_ror:4 row_mask:0xf bank_mask:0xf
    v_add_f32_dpp v19, v19, v19 row_ror:4 row_mask:0xf bank_mask:0xf
    v_cndmask_b32 v16, v16, v17, s[58:59]
    v_cndmask_b32 v18, v18, v19, s[58:59]
    v_cndmask_b32 v13, v16, v18, s[96:97]
    s_nop 1
    v_mfma_f32_16x16x4_f32 v[216:219], v13, v207, 0
    v_rcp_f32 v12, v220
    s_nop 8
    v_pk_mul_f32 v[16:17], v[12:13], v[216:217] op_sel_hi:[0,1]
    v_pk_mul_f32 v[18:19], v[12:13], v[218:219] op_sel_hi:[0,1]
    v_cvt_pk_bf16_f32 v16, v16, v16
    v_cvt_pk_bf16_f32 v17, v17, v17
    v_cvt_pk_bf16_f32 v18, v18, v18
    v_cvt_pk_bf16_f32 v19, v19, v19
    v_and_b32 v96, v16, v196
    v_and_b32 v97, v16, v197
    v_and_b32 v98, v16, v198
    v_and_b32 v99, v16, v199
    v_and_b32 v100, v17, v196
    v_and_b32 v101, v17, v197
    v_and_b32 v102, v17, v198
    v_and_b32 v103, v17, v199
    v_mfma_f32_16x16x32_bf16 v[224:227], v[32:35], v[96:99], 0
    v_mfma_f32_16x16x32_bf16 v[228:231], v[48:51], v[96:99], 0
    v_and_b32 v104, v18, v196
    v_and_b32 v105, v18, v197
    v_and_b32 v106, v18, v198
    v_and_b32 v107, v18, v199
    v_mfma_f32_16x16x32_bf16 v[224:227], v[36:39], v[100:103], v[224:227]
    v_mfma_f32_16x16x32_bf16 v[228:231], v[52:55], v[100:103], v[228:231]
    v_and_b32 v108, v19, v196
    v_and_b32 v109, v19, v197
    v_and_b32 v110, v19, v198
    v_and_b32 v111, v19, v199
    v_mfma_f32_16x16x32_bf16 v[224:227], v[40:43], v[104:107], v[224:227]
    v_mfma_f32_16x16x32_bf16 v[228:231], v[56:59], v[104:107], v[228:231]
    v_mfma_f32_16x16x32_bf16 v[224:227], v[44:47], v[108:111], v[224:227]
    v_mfma_f32_16x16x32_bf16 v[228:231], v[60:63], v[108:111], v[228:231]
    s_nop 7
    v_cndmask_b32 v24, v224, v228, s[6:7]
    v_cndmask_b32 v25, v225, v229, s[6:7]
    v_cndmask_b32 v26, v226, v230, s[6:7]
    v_cndmask_b32 v27, v227, v231, s[6:7]
    v_add_u32 v28, 0x800, v24
    v_add_u32 v29, 0x800, v25
    v_add_u32 v30, 0x800, v26
    v_add_u32 v31, 0x800, v27
    v_bfi_b32 v28, s63, v200, v28
    v_bfi_b32 v29, s63, v201, v29
    v_bfi_b32 v30, s63, v202, v30
    v_bfi_b32 v31, s63, v203, v31
    s_mov_b64 exec, s[8:9]
    buffer_store_dwordx4 v[28:31], v4, s[36:39], s52 offen
    v_mov_b32 v8, 0
    ds_read_b32 v8, v8 offset:3076
    s_waitcnt lgkmcnt(0)
    v_cmp_eq_u32 vcc, 0, v8
    s_nop 0
    s_cbranch_vccnz L_end
    buffer_store_dwordx4 v[28:31], v4, s[36:39], s53 offen sc1
    s_mov_b64 exec, -1
    s_branch L_end
L_R:
    s_sub_u32 s50, s33, 23
    s_lshl_b32 s52, s50, 2
    s_add_u32 s52, s52, s35
    s_lshl_b32 s54, s32, 16
    s_lshl_b32 s63, s52, 6
    s_add_u32 s54, s54, s63
    s_mul_i32 s53, s52, 128
    s_add_u32 s53, s53, 4096
    s_lshl_b32 s51, s32, 12
    s_add_u32 s51, s51, s53
    s_lshl_b32 s55, s32, 11
    s_lshl_b32 s63, s52, 6
    s_add_u32 s55, s55, s63
    s_add_u32 s55, s55, 36864
    v_lshlrev_b32 v4, 4, v2
    s_lshr_b32 s63, s52, 1
    s_lshl_b32 s63, s63, 6
    s_and_b32 s48, s52, 1
    s_lshl_b32 s48, s48, 3
    s_add_u32 s63, s63, s48
    v_lshl_add_u32 v215, v2, 4, s63
    s_mov_b32 s44, s4
    s_and_b32 s45, s5, 0xffff
    s_mov_b32 s46, 896
    s_mov_b32 s47, 0x20000
    buffer_load_dwordx2 v[210:211], v215, s[44:47], 0 offen
    v_and_b32 v8, 7, v1
    v_lshlrev_b32 v8, 12, v8
    v_lshl_add_u32 v249, v2, 4, v8
    s_barrier
    v_mov_b32 v5, 0
L_wc_2:
    ds_read_b32 v7, v5 offset:3072
    s_sub_u32 s62, s62, 1
    s_cbranch_scc1 L_end
    s_sleep 1
    s_waitcnt lgkmcnt(0)
    v_cmp_gt_u32 vcc, 6, v7
    s_nop 0
    s_cbranch_vccnz L_wc_2
    s_mov_b32 s3, 0
    s_sub_u32 s1, s62, 64
    s_add_u32 s48, s54, s3
    s_add_u32 s49, s48, 688128
    s_add_u32 s48, s48, 655360
    buffer_load_dwordx4 v[144:147], v213, s[36:39], s48 offen sc1
    buffer_load_dwordx4 v[148:151], v213, s[36:39], s49 offen sc1
L_e3apoll:
    s_waitcnt vmcnt(0)
    v_xor_b32 v12, v144, v200
    v_xor_b32 v13, v145, v201
    v_xor_b32 v14, v146, v202
    v_xor_b32 v15, v147, v203
    v_xor_b32 v16, v148, v200
    v_xor_b32 v17, v149, v201
    v_xor_b32 v18, v150, v202
    v_xor_b32 v19, v151, v203
    v_or3_b32 v5, v12, v13, v14
    v_or3_b32 v6, v15, v16, v17
    v_or3_b32 v5, v5, v18, v19
    v_or_b32 v5, v5, v6
    v_and_b32 v5, 0xfff, v5
    v_cmp_ne_u32 vcc, 0, v5
    s_nop 0
    s_cbranch_vccz L_e3apoll_ok
    s_sub_u32 s62, s62, 1
    s_cbranch_scc1 L_end
    s_xor_b32 s63, s3, 1179648
    s_cmp_lt_u32 s62, s1
    s_cselect_b32 s3, s63, s3
    s_add_u32 s48, s54, s3
    s_add_u32 s49, s48, 688128
    s_add_u32 s48, s48, 655360
    buffer_load_dwordx4 v[144:147], v213, s[36:39], s48 offen sc1
    buffer_load_dwordx4 v[148:151], v213, s[36:39], s49 offen sc1
    s_branch L_e3apoll
L_e3apoll_ok:
    v_pk_add_f32 v[12:13], v[12:13], v[16:17]
    v_pk_add_f32 v[14:15], v[14:15], v[18:19]
    s_nop 0
    v_add_f32_dpp v12, v12, v12 row_ror:8 row_mask:0xf bank_mask:0xf
    v_add_f32_dpp v13, v13, v13 row_ror:8 row_mask:0xf bank_mask:0xf
    v_add_f32_dpp v14, v14, v14 row_ror:8 row_mask:0xf bank_mask:0xf
    v_add_f32_dpp v15, v15, v15 row_ror:8 row_mask:0xf bank_mask:0xf
    v_add_f32_dpp v12, v12, v12 row_ror:4 row_mask:0xf bank_mask:0xf
    v_add_f32_dpp v13, v13, v13 row_ror:4 row_mask:0xf bank_mask:0xf
    v_add_f32_dpp v14, v14, v14 row_ror:4 row_mask:0xf bank_mask:0xf
    v_add_f32_dpp v15, v15, v15 row_ror:4 row_mask:0xf bank_mask:0xf
    v_cndmask_b32 v12, v12, v13, s[58:59]
    v_cndmask_b32 v14, v14, v15, s[58:59]
    v_cndmask_b32 v9, v12, v14, s[96:97]
    s_nop 1
    v_mfma_f32_16x16x4_f32 v[216:219], v9, v207, 0
    s_movk_i32 s63, 0xfff
    s_mov_b32 exec_lo, 0x00010001
    s_mov_b32 exec_hi, 0x00010001
    s_nop 6
    v_add_u32 v28, 0x800, v216
    v_add_u32 v29, 0x800, v217
    v_add_u32 v30, 0x800, v218
    v_add_u32 v31, 0x800, v219
    v_bfi_b32 v28, s63, v200, v28
    v_bfi_b32 v29, s63, v201, v29
    v_bfi_b32 v30, s63, v202, v30
    v_bfi_b32 v31, s63, v203, v31
    buffer_store_dwordx4 v[28:31], v4, s[36:39], s51 offen sc1
    buffer_store_dwordx4 v[28:31], v4, s[36:39], s55 offen
    s_mov_b64 exec, -1
    s_cmp_lg_u32 s50, s32
    s_cbranch_scc1 L_end
L_hpoll:
    s_sleep 2
    buffer_load_dwordx4 v[232:235], v249, s[36:39], s53 offen sc1
    s_waitcnt vmcnt(0)
    v_xor_b32 v12, v232, v200
    v_xor_b32 v13, v233, v201
    v_xor_b32 v14, v234, v202
    v_xor_b32 v15, v235, v203
    v_or3_b32 v5, v12, v13, v14
    v_or_b32 v5, v5, v15
    v_and_b32 v5, 0xfff, v5
    v_cmp_ne_u32 vcc, 0, v5
    s_nop 0
    s_cbranch_vccz L_hok
    s_sub_u32 s62, s62, 1
    s_cbranch_scc1 L_end
    s_branch L_hpoll
L_hok:
    v_add_f32_dpp v12, v12, v12 quad_perm:[1,0,3,2] row_mask:0xf bank_mask:0xf
    v_add_f32_dpp v13, v13, v13 quad_perm:[1,0,3,2] row_mask:0xf bank_mask:0xf
    v_add_f32_dpp v14, v14, v14 quad_perm:[1,0,3,2] row_mask:0xf bank_mask:0xf
    v_add_f32_dpp v15, v15, v15 quad_perm:[1,0,3,2] row_mask:0xf bank_mask:0xf
    v_add_f32_dpp v12, v12, v12 quad_perm:[2,3,0,1] row_mask:0xf bank_mask:0xf
    v_add_f32_dpp v13, v13, v13 quad_perm:[2,3,0,1] row_mask:0xf bank_mask:0xf
    v_add_f32_dpp v14, v14, v14 quad_perm:[2,3,0,1] row_mask:0xf bank_mask:0xf
    v_add_f32_dpp v15, v15, v15 quad_perm:[2,3,0,1] row_mask:0xf bank_mask:0xf
    v_add_f32_dpp v12, v12, v12 row_half_mirror row_mask:0xf bank_mask:0xf
    v_add_f32_dpp v13, v13, v13 row_half_mirror row_mask:0xf bank_mask:0xf
    v_add_f32_dpp v14, v14, v14 row_half_mirror row_mask:0xf bank_mask:0xf
    v_add_f32_dpp v15, v15, v15 row_half_mirror row_mask:0xf bank_mask:0xf
    v_mov_b32 v216, v12
    v_mov_b32 v217, v13
    v_mov_b32 v218, v14
    v_mov_b32 v219, v15
    v_lshlrev_b32 v208, 16, v210
    v_and_b32 v209, 0xffff0000, v210
    v_lshlrev_b32 v210, 16, v211
    v_and_b32 v211, 0xffff0000, v211
    v_cvt_pk_bf16_f32 v10, v216, v217
    v_cvt_pk_bf16_f32 v11, v218, v219
    v_lshlrev_b32 v12, 16, v10
    v_and_b32 v13, 0xffff0000, v10
    v_lshlrev_b32 v14, 16, v11
    v_and_b32 v15, 0xffff0000, v11
    v_pk_add_f32 v[12:13], v[12:13], v[208:209]
    v_pk_add_f32 v[14:15], v[14:15], v[210:211]
    v_cvt_pk_bf16_f32 v10, v12, v13
    v_cvt_pk_bf16_f32 v11, v14, v15
    v_lshlrev_b32 v208, 16, v10
    v_and_b32 v209, 0xffff0000, v10
    v_lshlrev_b32 v210, 16, v11
    v_and_b32 v211, 0xffff0000, v11
    s_lshl_b32 s48, s52, 6
    s_add_u32 s48, s48, 2359296
    s_add_u32 s49, s48, 32768
    s_add_u32 s50, s48, 65536
    s_add_u32 s51, s48, 98304
    v_mov_b32 v244, v200
    v_mov_b32 v245, v201
    v_mov_b32 v246, v202
    v_mov_b32 v247, v203
    s_mov_b32 s44, s22
    s_and_b32 s45, s23, 0xffff
    s_mov_b32 s46, 896
    s_mov_b32 s47, 0x20000
    buffer_load_dwordx4 v[232:235], v213, s[36:39], s48 offen sc1
    buffer_load_dwordx4 v[236:239], v213, s[36:39], s49 offen sc1
    buffer_load_dwordx4 v[240:243], v213, s[36:39], s50 offen sc1
    s_mov_b32 exec_hi, 0
    buffer_load_dwordx4 v[244:247], v213, s[36:39], s51 offen sc1
    s_mov_b64 exec, -1
L_e4poll:
    s_waitcnt vmcnt(0)
    v_xor_b32 v112, v232, v200
    v_xor_b32 v113, v233, v201
    v_xor_b32 v114, v234, v202
    v_xor_b32 v115, v235, v203
    v_xor_b32 v116, v236, v200
    v_xor_b32 v117, v237, v201
    v_xor_b32 v118, v238, v202
    v_xor_b32 v119, v239, v203
    v_xor_b32 v120, v240, v200
    v_xor_b32 v121, v241, v201
    v_xor_b32 v122, v242, v202
    v_xor_b32 v123, v243, v203
    v_xor_b32 v124, v244, v200
    v_xor_b32 v125, v245, v201
    v_xor_b32 v126, v246, v202
    v_xor_b32 v127, v247, v203
    v_or3_b32 v5, v112, v113, v114
    v_or3_b32 v6, v115, v116, v117
    v_or3_b32 v7, v118, v119, v120
    v_or3_b32 v5, v5, v121, v122
    v_or3_b32 v6, v6, v123, v124
    v_or3_b32 v7, v7, v125, v126
    v_or3_b32 v5, v5, v6, v7
    v_or_b32 v5, v5, v127
    v_and_b32 v5, 0xfff, v5
    v_cmp_ne_u32 vcc, 0, v5
    s_nop 0
    s_cbranch_vccz L_e4poll_ok
    s_sub_u32 s62, s62, 1
    s_cbranch_scc1 L_end
    buffer_load_dwordx4 v[232:235], v213, s[36:39], s48 offen sc1
    buffer_load_dwordx4 v[236:239], v213, s[36:39], s49 offen sc1
    buffer_load_dwordx4 v[240:243], v213, s[36:39], s50 offen sc1
    s_mov_b32 exec_hi, 0
    buffer_load_dwordx4 v[244:247], v213, s[36:39], s51 offen sc1
    s_mov_b64 exec, -1
    s_branch L_e4poll
L_e4poll_ok:
    v_pk_add_f32 v[112:113], v[112:113], v[116:117]
    v_pk_add_f32 v[114:115], v[114:115], v[118:119]
    v_pk_add_f32 v[120:121], v[120:121], v[124:125]
    v_pk_add_f32 v[122:123], v[122:123], v[126:127]
    v_pk_add_f32 v[112:113], v[112:113], v[120:121]
    v_pk_add_f32 v[114:115], v[114:115], v[122:123]
    s_nop 0
    v_add_f32_dpp v112, v112, v112 row_ror:8 row_mask:0xf bank_mask:0xf
    v_add_f32_dpp v113, v113, v113 row_ror:8 row_mask:0xf bank_mask:0xf
    v_add_f32_dpp v114, v114, v114 row_ror:8 row_mask:0xf bank_mask:0xf
    v_add_f32_dpp v115, v115, v115 row_ror:8 row_mask:0xf bank_mask:0xf
    v_add_f32_dpp v112, v112, v112 row_ror:4 row_mask:0xf bank_mask:0xf
    v_add_f32_dpp v113, v113, v113 row_ror:4 row_mask:0xf bank_mask:0xf
    v_add_f32_dpp v114, v114, v114 row_ror:4 row_mask:0xf bank_mask:0xf
    v_add_f32_dpp v115, v115, v115 row_ror:4 row_mask:0xf bank_mask:0xf
    v_cndmask_b32 v112, v112, v113, s[58:59]
    v_cndmask_b32 v114, v114, v115, s[58:59]
    v_cndmask_b32 v9, v112, v114, s[96:97]
    s_nop 1
    v_mfma_f32_16x16x4_f32 v[216:219], v9, v207, 0
    s_nop 9
    v_cvt_pk_bf16_f32 v10, v216, v217
    v_cvt_pk_bf16_f32 v11, v218, v219
    v_lshlrev_b32 v12, 16, v10
    v_and_b32 v13, 0xffff0000, v10
    v_lshlrev_b32 v14, 16, v11
    v_and_b32 v15, 0xffff0000, v11
    v_pk_add_f32 v[12:13], v[12:13], v[208:209]
    v_pk_add_f32 v[14:15], v[14:15], v[210:211]
    v_cvt_pk_bf16_f32 v10, v12, v13
    v_cvt_pk_bf16_f32 v11, v14, v15
    s_mov_b32 exec_lo, 0x00010001
    s_mov_b32 exec_hi, 0x00010001
    buffer_store_dwordx2 v[10:11], v215, s[44:47], 0 offen
    s_cmp_lg_u32 s52, 0
    s_cbranch_scc1 L_noep
    s_mov_b32 exec_lo, 0x00000001
    s_mov_b32 exec_hi, 0x00000000
    v_mov_b32 v9, 0
    v_mov_b32 v12, s28
    v_mov_b32 v13, s29
    v_mov_b32 v14, s30
    v_mov_b32 v15, s31
    buffer_store_dwordx4 v[12:15], v9, s[36:39], 0 offen offset:0
L_noep:
    s_mov_b64 exec, -1
    s_branch L_end
L_F:
    s_mul_i32 s50, s32, 7
    s_add_u32 s50, s50, s33
    s_sub_u32 s50, s50, 16
    s_lshl_b32 s51, s50, 2
    s_add_u32 s51, s51, s35
    v_lshrrev_b32 v8, 3, v1
    v_sub_u32 v8, v1, v8
    v_min_u32 v8, 13, v8
    v_lshlrev_b32 v8, 6, v8
    v_lshl_add_u32 v23, v2, 4, v8
    s_mov_b32 exec_lo, 0x80808080
    s_mov_b32 exec_hi, 0x80808080
    v_mov_b32 v23, 896
    v_mov_b32 v12, 0
    v_mov_b32 v13, 0
    v_mov_b32 v14, 0
    v_mov_b32 v15, 0
    ds_write_b128 v23, v[12:15] offset:3136
    s_mov_b64 exec, -1
    v_bfe_u32 v8, v3, 2, 3
    v_min_u32 v8, 6, v8
    v_and_b32 v9, 3, v3
    v_mul_u32_u24 v10, 128, v8
    v_lshl_add_u32 v10, v9, 4, v10
    v_lshrrev_b32 v11, 5, v3
    v_lshl_add_u32 v215, v11, 12, v10
    s_mul_i32 s63, s35, 7
    v_add_u32 v8, s63, v8
    v_lshrrev_b32 v10, 1, v8
    v_lshlrev_b32 v10, 6, v10
    v_and_b32 v8, 1, v8
    v_lshl_add_u32 v10, v8, 3, v10
    v_lshl_add_u32 v24, v9, 4, v10
    v_and_b32 v10, 1, v2
    v_and_b32 v11, 1, v1
    v_lshlrev_b32 v25, 2, v10
    v_and_b32 v26, 2, v2
    v_add_u32 v25, v25, v26
    v_mul_u32_u24 v26, 896, v25
    v_lshl_add_u32 v26, v1, 4, v26
    v_add_u32 v25, v25, v11
    v_lshlrev_b32 v25, 1, v25
    v_bfe_u32 v27, v1, 1, 1
    v_mul_u32_u24 v27, 14336, v27
    v_lshl_add_u32 v27, v2, 9, v27
    v_lshrrev_b32 v12, 2, v1
    v_lshl_add_u32 v27, v12, 6, v27
    v_lshl_add_u32 v27, v11, 3, v27
    s_lshl_b32 s63, s35, 4
    v_add_u32 v248, s63, v27
    v_lshrrev_b32 v27, 2, v3
    v_mul_u32_u24 v27, 3584, v27
    v_and_b32 v12, 3, v3
    v_lshl_add_u32 v27, v12, 4, v27
    s_lshl_b32 s63, s35, 11
    v_lshl_add_u32 v249, v3, 4, s63
    s_mov_b32 s40, s16
    s_and_b32 s41, s17, 0xffff
    s_mov_b32 s42, 1605632
    s_mov_b32 s43, 0x20000
    s_mov_b32 s44, s20
    s_and_b32 s45, s21, 0xffff
    s_mov_b32 s46, 1605632
    s_mov_b32 s47, 0x20000
    s_mov_b32 s8, s4
    s_and_b32 s9, s5, 0xffff
    s_mov_b32 s10, 896
    s_mov_b32 s11, 0x20000
    s_mov_b32 s12, s18
    s_and_b32 s13, s19, 0xffff
    s_mov_b32 s14, 3584
    s_mov_b32 s15, 0x20000
    s_mul_i32 s52, s35, 401408
    s_lshl_b32 s63, s50, 6
    s_add_u32 s52, s52, s63
    s_mul_i32 s53, s35, 7168
    s_add_u32 s53, s53, 12288
    s_mul_i32 s54, s51, 7168
    s_lshl_b32 s55, s51, 4
    s_mul_i32 s24, s35, 896
    s_add_u32 s24, s24, 4096
    s_add_u32 s25, s24, 8192
    s_add_u32 s26, s24, 16384
    s_add_u32 s27, s24, 24576
    s_mov_b32 s6, 57344
    s_movk_i32 s7, 1024
    s_bitcmp1_b32 s50, 0
    s_cbranch_scc0 L_nozig
    s_add_u32 s52, s52, 344064
    s_add_u32 s53, s53, 6144
    s_mov_b32 s6, -57344
    s_movk_i32 s7, -1024
L_nozig:
    s_barrier
    buffer_load_dwordx4 v[32:35], v26, s[44:47], s54 offen offset:0 nt
    buffer_load_dwordx4 v[36:39], v26, s[44:47], s54 offen offset:896 nt
    buffer_load_dwordx4 v[40:43], v26, s[44:47], s54 offen offset:256 nt
    buffer_load_dwordx4 v[44:47], v26, s[44:47], s54 offen offset:1152 nt
    buffer_load_dwordx4 v[48:51], v26, s[44:47], s54 offen offset:512 nt
    buffer_load_dwordx4 v[52:55], v26, s[44:47], s54 offen offset:1408 nt
    s_mov_b32 exec_lo, 0x00ff00ff
    s_mov_b32 exec_hi, 0x00ff00ff
    buffer_load_dwordx4 v[56:59], v26, s[44:47], s54 offen offset:768 nt
    buffer_load_dwordx4 v[60:63], v26, s[44:47], s54 offen offset:1664 nt
    s_mov_b64 exec, -1
    buffer_load_dwordx2 v[210:211], v24, s[8:11], 0 offen
    buffer_load_ushort v212, v25, s[12:15], s55 offen
    v_mov_b32 v5, 0
L_wc_3:
    ds_read_b32 v7, v5 offset:3072
    s_sub_u32 s62, s62, 1
    s_cbranch_scc1 L_end
    s_sleep 1
    s_waitcnt lgkmcnt(0)
    v_cmp_gt_u32 vcc, 6, v7
    s_nop 0
    s_cbranch_vccnz L_wc_3
    s_mov_b32 m0, s53
    s_nop 0
    buffer_load_dwordx4 v27, s[40:43], s52 offen lds
    s_add_u32 s52, s52, s6
    s_add_u32 s53, s53, s7
    s_mov_b32 m0, s53
    s_nop 0
    buffer_load_dwordx4 v27, s[40:43], s52 offen lds
    s_add_u32 s52, s52, s6
    s_add_u32 s53, s53, s7
    s_mov_b32 m0, s53
    s_nop 0
    buffer_load_dwordx4 v27, s[40:43], s52 offen lds
    s_add_u32 s52, s52, s6
    s_add_u32 s53, s53, s7
    s_mov_b32 m0, s53
    s_nop 0
    buffer_load_dwordx4 v27, s[40:43], s52 offen lds
    s_add_u32 s52, s52, s6
    s_add_u32 s53, s53, s7
    s_mov_b32 m0, s53
    s_nop 0
    buffer_load_dwordx4 v27, s[40:43], s52 offen lds
    s_add_u32 s52, s52, s6
    s_add_u32 s53, s53, s7
    s_mov_b32 m0, s53
    s_nop 0
    buffer_load_dwordx4 v27, s[40:43], s52 offen lds
    s_add_u32 s52, s52, s6
    s_add_u32 s53, s53, s7
    s_mov_b32 m0, s53
    s_nop 0
    buffer_load_dwordx4 v27, s[40:43], s52 offen lds
    s_lshl_b32 s48, s50, 11
    s_lshl_b32 s63, s35, 10
    s_add_u32 s48, s48, s63
    s_add_u32 s48, s48, 2359296
    v_cmp_lt_u32 s[6:7], 7, v1
    v_add_u32 v4, 384, v214
    s_nop 0
    v_cndmask_b32 v4, v214, v4, s[6:7]
    s_lshl_b32 s63, s35, 10
    v_lshl_add_u32 v21, v3, 4, s63
    v_min_u32 v22, 27, v3
    v_lshlrev_b32 v22, 4, v22
    s_lshl_b32 s49, s32, 11
    s_mul_i32 s63, s35, 448
    s_add_u32 s49, s49, s63
    s_add_u32 s49, s49, 36864
    s_mov_b32 s1, 64
    s_waitcnt vmcnt(0)
    s_barrier
    ds_read_b64_tr_b16 v[64:65], v248 offset:12288
    ds_read_b64_tr_b16 v[66:67], v248 offset:12544
    ds_read_b64_tr_b16 v[68:69], v248 offset:14336
    ds_read_b64_tr_b16 v[70:71], v248 offset:14592
    ds_read_b64_tr_b16 v[72:73], v248 offset:16384
    ds_read_b64_tr_b16 v[74:75], v248 offset:16640
    ds_read_b64_tr_b16 v[76:77], v248 offset:18432
    ds_read_b64_tr_b16 v[78:79], v248 offset:18688
    ds_read_b64_tr_b16 v[80:81], v248 offset:20480
    ds_read_b64_tr_b16 v[82:83], v248 offset:20736
    ds_read_b64_tr_b16 v[84:85], v248 offset:22528
    ds_read_b64_tr_b16 v[86:87], v248 offset:22784
    ds_read_b64_tr_b16 v[88:89], v248 offset:24576
    ds_read_b64_tr_b16 v[90:91], v248 offset:24832
    v_lshlrev_b32 v212, 16, v212
    v_lshlrev_b32 v208, 16, v210
    v_and_b32 v209, 0xffff0000, v210
    v_lshlrev_b32 v210, 16, v211
    v_and_b32 v211, 0xffff0000, v211
    v_mov_b32 v176, 0x3f803f80
    v_mov_b32 v177, 0x3f803f80
    v_mov_b32 v178, 0x3f803f80
    v_mov_b32 v179, 0x3f803f80
    s_waitcnt lgkmcnt(0)
    s_nop 0
    v_mfma_f32_16x16x32_bf16 v[144:147], v[176:179], v[64:67], 0
    v_mfma_f32_16x16x32_bf16 v[148:151], v[176:179], v[68:71], 0
    v_mfma_f32_16x16x32_bf16 v[152:155], v[176:179], v[72:75], 0
    v_mfma_f32_16x16x32_bf16 v[156:159], v[176:179], v[76:79], 0
    v_mfma_f32_16x16x32_bf16 v[160:163], v[176:179], v[80:83], 0
    v_mfma_f32_16x16x32_bf16 v[164:167], v[176:179], v[84:87], 0
    v_mfma_f32_16x16x32_bf16 v[168:171], v[176:179], v[88:91], 0
    v_mov_b32 v251, 0
    s_mov_b32 exec_lo, 0x000000ff
    s_mov_b32 exec_hi, 0x0000ff00
    v_add_f32 v251, v144, v149
    s_nop 0
    v_add_f32 v9, v154, v159
    v_add_f32 v251, v251, v9
    s_mov_b32 exec_lo, 0x00ff0000
    s_mov_b32 exec_hi, 0xff000000
    v_add_f32 v251, v160, v165
    v_add_f32 v251, v251, v170
    s_mov_b64 exec, -1
    s_nop 0
    v_add_f32_dpp v251, v251, v251 row_ror:8 row_mask:0xf bank_mask:0xf
    s_nop 1
    v_mfma_f32_16x16x4_f32 v[216:219], v251, v207, 0
    s_nop 9
    v_cndmask_b32 v251, v216, v217, s[56:57]
    v_cndmask_b32 v9, v218, v219, s[56:57]
    v_cndmask_b32 v251, v251, v9, s[60:61]
L_lh:
    buffer_load_dwordx4 v[232:235], v22, s[36:39], s49 offen sc1
    s_sub_u32 s1, s1, 1
    s_cbranch_scc1 L_lhok
    s_waitcnt vmcnt(0)
    v_xor_b32 v112, v232, v200
    v_xor_b32 v113, v233, v201
    v_xor_b32 v114, v234, v202
    v_xor_b32 v115, v235, v203
    v_or3_b32 v5, v112, v113, v114
    v_or_b32 v5, v5, v115
    v_and_b32 v5, 0xfff, v5
    v_cmp_ne_u32 vcc, 0, v5
    s_nop 0
    s_cbranch_vccz L_lhok
    s_branch L_lh
L_lhok:
    buffer_load_dwordx4 v[232:235], v215, s[36:39], s24 offen sc1
    buffer_load_dwordx4 v[236:239], v215, s[36:39], s25 offen sc1
    buffer_load_dwordx4 v[240:243], v215, s[36:39], s26 offen sc1
    buffer_load_dwordx4 v[244:247], v215, s[36:39], s27 offen sc1
L_e3xpoll:
    s_waitcnt vmcnt(0)
    v_xor_b32 v112, v232, v200
    v_xor_b32 v113, v233, v201
    v_xor_b32 v114, v234, v202
    v_xor_b32 v115, v235, v203
    v_xor_b32 v116, v236, v200
    v_xor_b32 v117, v237, v201
    v_xor_b32 v118, v238, v202
    v_xor_b32 v119, v239, v203
    v_xor_b32 v120, v240, v200
    v_xor_b32 v121, v241, v201
    v_xor_b32 v122, v242, v202
    v_xor_b32 v123, v243, v203
    v_xor_b32 v124, v244, v200
    v_xor_b32 v125, v245, v201
    v_xor_b32 v126, v246, v202
    v_xor_b32 v127, v247, v203
    v_or3_b32 v5, v112, v113, v114
    v_or3_b32 v6, v115, v116, v117
    v_or3_b32 v7, v118, v119, v120
    v_or3_b32 v5, v5, v121, v122
    v_or3_b32 v6, v6, v123, v124
    v_or3_b32 v7, v7, v125, v126
    v_or3_b32 v5, v5, v6, v7
    v_or_b32 v5, v5, v127
    v_and_b32 v5, 0xfff, v5
    v_cmp_ne_u32 vcc, 0, v5
    s_nop 0
    s_cbranch_vccz L_e3xpoll_ok
    s_sub_u32 s62, s62, 1
    s_cbranch_scc1 L_end
    buffer_load_dwordx4 v[232:235], v215, s[36:39], s24 offen sc1
    buffer_load_dwordx4 v[236:239], v215, s[36:39], s25 offen sc1
    buffer_load_dwordx4 v[240:243], v215, s[36:39], s26 offen sc1
    buffer_load_dwordx4 v[244:247], v215, s[36:39], s27 offen sc1
    s_branch L_e3xpoll
L_e3xpoll_ok:
    v_pk_add_f32 v[112:113], v[112:113], v[116:117]
    v_pk_add_f32 v[114:115], v[114:115], v[118:119]
    v_pk_add_f32 v[120:121], v[120:121], v[124:125]
    v_pk_add_f32 v[122:123], v[122:123], v[126:127]
    v_pk_add_f32 v[112:113], v[112:113], v[120:121]
    v_pk_add_f32 v[114:115], v[114:115], v[122:123]
    v_pk_mov_b32 v[116:117], v[112:113], v[112:113] op_sel:[0,1]
    v_pk_mov_b32 v[118:119], v[114:115], v[114:115] op_sel:[0,1]
    s_nop 0
    v_permlane32_swap_b32 v112, v116
    v_permlane32_swap_b32 v113, v117
    v_permlane32_swap_b32 v114, v118
    v_permlane32_swap_b32 v115, v119
    v_pk_add_f32 v[112:113], v[112:113], v[116:117]
    v_pk_add_f32 v[114:115], v[114:115], v[118:119]
    v_cvt_pk_bf16_f32 v10, v112, v113
    v_cvt_pk_bf16_f32 v11, v114, v115
    v_lshlrev_b32 v12, 16, v10
    v_and_b32 v13, 0xffff0000, v10
    v_lshlrev_b32 v14, 16, v11
    v_and_b32 v15, 0xffff0000, v11
    v_pk_add_f32 v[12:13], v[12:13], v[208:209]
    v_pk_add_f32 v[14:15], v[14:15], v[210:211]
    v_cvt_pk_bf16_f32 v10, v12, v13
    v_cvt_pk_bf16_f32 v11, v14, v15
    ds_write_b64 v24, v[10:11] offset:3136
    s_waitcnt lgkmcnt(0)
    s_barrier
    ds_read_b128 v[176:179], v23 offset:3136
    s_waitcnt lgkmcnt(0)
    v_mfma_f32_16x16x32_bf16 v[144:147], v[176:179], v[64:67], 0
    v_lshlrev_b32 v112, 16, v176
    v_and_b32 v113, 0xffff0000, v176
    v_mfma_f32_16x16x32_bf16 v[148:151], v[176:179], v[68:71], 0
    v_lshlrev_b32 v114, 16, v177
    v_and_b32 v115, 0xffff0000, v177
    v_mfma_f32_16x16x32_bf16 v[152:155], v[176:179], v[72:75], 0
    v_lshlrev_b32 v116, 16, v178
    v_and_b32 v117, 0xffff0000, v178
    v_mfma_f32_16x16x32_bf16 v[156:159], v[176:179], v[76:79], 0
    v_lshlrev_b32 v118, 16, v179
    v_and_b32 v119, 0xffff0000, v179
    v_mfma_f32_16x16x32_bf16 v[160:163], v[176:179], v[80:83], 0
    v_readlane_b32 s24, v112, 0
    v_mov_b32 v13, 0
    v_mov_b32 v14, 0
    v_mfma_f32_16x16x32_bf16 v[164:167], v[176:179], v[84:87], 0
    v_mov_b32 v22, 0
    v_mfma_f32_16x16x32_bf16 v[168:171], v[176:179], v[88:91], 0
    s_mov_b32 exec_lo, 0x7f7f7f7f
    s_mov_b32 exec_hi, 0x7f7f7f7f
    s_mov_b32 s63, s24
    v_pk_add_f32 v[120:121], v[112:113], s[24:25] op_sel_hi:[1,0] neg_lo:[0,1] neg_hi:[0,1]
    v_pk_add_f32 v[122:123], v[114:115], s[24:25] op_sel_hi:[1,0] neg_lo:[0,1] neg_hi:[0,1]
    v_pk_add_f32 v[124:125], v[116:117], s[24:25] op_sel_hi:[1,0] neg_lo:[0,1] neg_hi:[0,1]
    v_pk_add_f32 v[126:127], v[118:119], s[24:25] op_sel_hi:[1,0] neg_lo:[0,1] neg_hi:[0,1]
    v_pk_add_f32 v[128:129], v[120:121], v[122:123]
    v_pk_mul_f32 v[130:131], v[120:121], v[120:121]
    v_pk_add_f32 v[132:133], v[124:125], v[126:127]
    v_pk_fma_f32 v[130:131], v[122:123], v[122:123], v[130:131]
    v_pk_add_f32 v[128:129], v[128:129], v[132:133]
    v_pk_fma_f32 v[130:131], v[124:125], v[124:125], v[130:131]
    v_add_f32 v13, v128, v129
    v_pk_fma_f32 v[130:131], v[126:127], v[126:127], v[130:131]
    v_add_f32 v14, v130, v131
    s_mov_b32 exec_lo, 0x000000ff
    s_mov_b32 exec_hi, 0x0000ff00
    v_add_f32 v22, v144, v149
    v_add_f32 v20, v154, v159
    v_add_f32 v22, v22, v20
    s_mov_b32 exec_lo, 0x00ff0000
    s_mov_b32 exec_hi, 0xff000000
    v_add_f32 v22, v160, v165
    v_add_f32 v22, v22, v170
    s_mov_b64 exec, -1
    s_nop 0
    v_add_f32_dpp v22, v22, v22 row_ror:8 row_mask:0xf bank_mask:0xf
    s_nop 1
    v_mfma_f32_16x16x4_f32 v[216:219], v22, v207, 0
    v_add_f32_dpp v13, v13, v13 row_ror:8 row_mask:0xf bank_mask:0xf
    v_add_f32_dpp v14, v14, v14 row_ror:8 row_mask:0xf bank_mask:0xf
    s_nop 0
    v_add_f32_dpp v13, v13, v13 row_ror:4 row_mask:0xf bank_mask:0xf
    v_add_f32_dpp v14, v14, v14 row_ror:4 row_mask:0xf bank_mask:0xf
    s_nop 0
    v_add_f32_dpp v13, v13, v13 row_ror:2 row_mask:0xf bank_mask:0xf
    v_add_f32_dpp v14, v14, v14 row_ror:2 row_mask:0xf bank_mask:0xf
    s_nop 0
    v_add_f32_dpp v13, v13, v13 row_ror:1 row_mask:0xf bank_mask:0xf
    v_add_f32_dpp v14, v14, v14 row_ror:1 row_mask:0xf bank_mask:0xf
    v_mov_b32 v15, v13
    v_mov_b32 v16, v14
    s_nop 0
    v_permlane16_swap_b32 v13, v15
    v_permlane16_swap_b32 v14, v16
    v_add_f32 v13, v13, v15
    v_add_f32 v14, v14, v16
    v_mov_b32 v15, v13
    v_mov_b32 v16, v14
    s_nop 0
    v_permlane32_swap_b32 v13, v15
    v_permlane32_swap_b32 v14, v16
    v_add_f32 v13, v13, v15
    v_add_f32 v14, v14, v16
    v_mul_f32 v13, 0x3b124925, v13
    v_mul_f32 v14, 0x3b124925, v14
    v_fma_f32 v14, -v13, v13, v14
    v_add_f32 v13, s63, v13
    v_max_f32 v14, 0, v14
    v_cvt_pk_bf16_f32 v15, v13, v14
    v_and_b32 v14, 0xffff0000, v15
    v_lshlrev_b32 v13, 16, v15
    v_add_f32 v14, 0x3727c5ac, v14
    v_cvt_pk_bf16_f32 v14, v14, v14
    v_and_b32 v14, 0xffff0000, v14
    v_sqrt_f32 v14, v14
    v_cndmask_b32 v22, v216, v217, s[56:57]
    v_cndmask_b32 v20, v218, v219, s[56:57]
    v_cndmask_b32 v22, v22, v20, s[60:61]
    v_cvt_pk_bf16_f32 v14, v14, v14
    v_and_b32 v14, 0xffff0000, v14
    v_rcp_f32 v14, v14
    v_fma_f32 v8, -v13, v251, v22
    s_mov_b32 s63, 0xbfb8aa3b
    v_mul_f32 v8, v8, v14
    v_cvt_pk_bf16_f32 v8, v8, v8
    v_and_b32 v8, 0xffff0000, v8
    v_add_f32 v8, v8, v212
    v_cvt_pk_bf16_f32 v8, v8, v8
    v_and_b32 v8, 0xffff0000, v8
    v_mul_f32 v9, s63, abs(v8)
    v_exp_f32 v9, v9
    v_cmp_gt_f32 vcc, 0, v8
    v_mul_f32 v10, v9, v9
    s_nop 0
    v_cndmask_b32 v11, 1.0, v10, vcc
    v_cndmask_b32 v12, v10, 1.0, vcc
    v_fma_f32 v11, 2.0, v9, v11
    v_fma_f32 v12, 2.0, v12, v11
    v_rcp_f32 v12, v12
    s_nop 0
    v_mul_f32 v14, v11, v12
    v_mul_f32 v14, v14, v8
    v_cvt_pk_bf16_f32 v14, v14, v14
    s_movk_i32 s63, 0xfff
    s_nop 0
    v_and_b32_dpp v96, v14, v196 quad_perm:[0,0,2,2] row_mask:0xf bank_mask:0xf
    v_and_b32_dpp v97, v14, v197 quad_perm:[0,0,2,2] row_mask:0xf bank_mask:0xf
    v_and_b32_dpp v98, v14, v198 quad_perm:[0,0,2,2] row_mask:0xf bank_mask:0xf
    v_and_b32_dpp v99, v14, v199 quad_perm:[0,0,2,2] row_mask:0xf bank_mask:0xf
    v_and_b32_dpp v100, v14, v196 quad_perm:[1,1,3,3] row_mask:0xf bank_mask:0xf
    v_and_b32_dpp v101, v14, v197 quad_perm:[1,1,3,3] row_mask:0xf bank_mask:0xf
    v_and_b32_dpp v102, v14, v198 quad_perm:[1,1,3,3] row_mask:0xf bank_mask:0xf
    v_and_b32_dpp v103, v14, v199 quad_perm:[1,1,3,3] row_mask:0xf bank_mask:0xf
    v_mfma_f32_16x16x32_bf16 v[216:219], v[32:35], v[96:99], 0
    v_mfma_f32_16x16x32_bf16 v[220:223], v[40:43], v[96:99], 0
    v_mfma_f32_16x16x32_bf16 v[224:227], v[48:51], v[96:99], 0
    v_mfma_f32_16x16x32_bf16 v[228:231], v[56:59], v[96:99], 0
    v_mfma_f32_16x16x32_bf16 v[216:219], v[36:39], v[100:103], v[216:219]
    v_mfma_f32_16x16x32_bf16 v[220:223], v[44:47], v[100:103], v[220:223]
    v_mfma_f32_16x16x32_bf16 v[224:227], v[52:55], v[100:103], v[224:227]
    v_mfma_f32_16x16x32_bf16 v[228:231], v[60:63], v[100:103], v[228:231]
    s_mov_b32 exec_lo, 0x00ff00ff
    s_mov_b32 exec_hi, 0x00ff00ff
    s_nop 2
    ds_write_b128 v249, v[216:219] offset:4096
    s_not_b64 exec, exec
    ds_write_b128 v249, v[220:223] offset:4096
    s_not_b64 exec, exec
    ds_write_b128 v249, v[224:227] offset:5120
    s_not_b64 exec, exec
    ds_write_b128 v249, v[228:231] offset:5120
    s_mov_b64 exec, -1
    s_waitcnt lgkmcnt(0)
    s_barrier
    s_cmp_ge_u32 s35, 2
    s_cbranch_scc1 L_end
    ds_read_b128 v[112:115], v21 offset:4096
    ds_read_b128 v[116:119], v21 offset:6144
    ds_read_b128 v[120:123], v21 offset:8192
    ds_read_b128 v[124:127], v21 offset:10240
    s_cmp_eq_u32 s35, 1
    s_cselect_b32 exec_hi, 0x00ff00ff, -1
    s_waitcnt lgkmcnt(0)
    v_pk_add_f32 v[112:113], v[112:113], v[116:117]
    v_pk_add_f32 v[114:115], v[114:115], v[118:119]
    v_pk_add_f32 v[120:121], v[120:121], v[124:125]
    v_pk_add_f32 v[122:123], v[122:123], v[126:127]
    v_pk_add_f32 v[112:113], v[112:113], v[120:121]
    v_pk_add_f32 v[114:115], v[114:115], v[122:123]
    v_add_u32 v28, 0x800, v112
    v_add_u32 v29, 0x800, v113
    v_add_u32 v30, 0x800, v114
    v_add_u32 v31, 0x800, v115
    v_bfi_b32 v28, s63, v200, v28
    v_bfi_b32 v29, s63, v201, v29
    v_bfi_b32 v30, s63, v202, v30
    v_bfi_b32 v31, s63, v203, v31
    buffer_store_dwordx4 v[28:31], v4, s[36:39], s48 offen sc1
    s_mov_b64 exec, -1
L_end:
L_exit:
    s_endpgm
.section .rodata,"a"
.p2align 6
.amdhsa_kernel sequential_preLN__sliding_block_cached__dense_activation_mish__decode_kernel
  .amdhsa_next_free_vgpr 252
  .amdhsa_next_free_sgpr 100
  .amdhsa_accum_offset 252
  .amdhsa_group_segment_fixed_size 0
  .amdhsa_kernarg_size 96
  .amdhsa_user_sgpr_count 2
  .amdhsa_user_sgpr_kernarg_segment_ptr 1
  .amdhsa_system_sgpr_workgroup_id_x 1
  .amdhsa_float_denorm_mode_32 3
.end_amdhsa_kernel
```
